```python
import torch

def _softmax(x, axis=-1):
    return torch.softmax(x, dim=axis)
def _gelu(x):
    return torch.nn.functional.gelu(x, approximate="tanh")
def _silu(x):
    return torch.nn.functional.silu(x)
def _sigmoid(x):
    return torch.sigmoid(x)
def _layernorm(x, axis=-1, eps=1e-5):
    m = x.mean(dim=axis, keepdim=True)
    v = x.var(dim=axis, keepdim=True, unbiased=False)
    return (x - m) / torch.sqrt(v + eps)
def _scatter_add(tgt, idx, src, axis=0):
    return tgt.clone().index_add_(axis, idx, src)
def _segment_sum(src, seg, n):
    out = torch.zeros((n,) + src.shape[1:], dtype=src.dtype)
    return out.index_add_(0, seg, src)
def _pad(x, pw):
    flat = tuple(v for pair in reversed(pw) for v in pair)
    return torch.nn.functional.pad(x, flat)

kernel_name = 'standalone__swiglu_ffn__sampling'

def setup_inputs():

    _w = (lambda a: (lambda t: t.to(torch.bfloat16) if t.is_floating_point() else t)(torch.as_tensor(a)))
    B, S, D, F = 8, 16, 1024, 3584
    return {
        "x": _w((lambda *s: torch.randn(*s, dtype=torch.bfloat16) * 0.05)(B, S, D)),
        "w_gate": _w((lambda *s: torch.randn(*s, dtype=torch.bfloat16) * 0.05)(D, F)),
        "w_up": _w((lambda *s: torch.randn(*s, dtype=torch.bfloat16) * 0.05)(D, F)),
        "w_down": _w((lambda *s: torch.randn(*s, dtype=torch.bfloat16) * 0.05)(F, D)),
    }

def reference(x, w_gate, w_up, w_down):
    g = _silu(x @ w_gate)
    u = x @ w_up
    return (g * u) @ w_down
```

```asm
; @launch grid=(256,1,1) block=(512,1,1) lds=155712
.amdgcn_target "amdgcn-amd-amdhsa--gfx950"
.text
.globl standalone__swiglu_ffn__sampling_kernel
.p2align 8
.type standalone__swiglu_ffn__sampling_kernel,@function
standalone__swiglu_ffn__sampling_kernel:
    s_load_dwordx8 s[4:11], s[0:1], 0
    s_load_dwordx4 s[12:15], s[0:1], 32
    s_load_dwordx2 s[16:17], s[0:1], 48
    v_lshrrev_b32 v1, 6, v0
    s_cmp_ge_u32 s2, 256
    s_cbranch_scc1 L_end
    v_readfirstlane_b32 s53, v1
    s_and_b32 s48, s2, 7
    s_lshr_b32 s49, s2, 3
    v_and_b32 v2, 63, v0
    s_mov_b32 s22, 262144
    s_mov_b32 s23, 0x20000
    s_mov_b32 s26, 7340032
    s_mov_b32 s27, 0x20000
    s_cmp_eq_u32 s53, 1
    s_cbranch_scc0 L_nocp
    s_getpc_b64 s[44:45]
L_pc:
    v_and_b32 v3, 3, v2
    v_lshl_add_u32 v3, s49, 2, v3
    v_min_u32 v3, (L_code_end-L_pc-4)/128, v3
    v_lshlrev_b32 v3, 7, v3
    global_load_dword v31, v3, s[44:45]
L_nocp:
    s_cmp_lt_u32 s49, 14
    s_cbranch_scc1 L_p1
    s_sub_u32 s52, s49, 14
    s_cmp_lg_u32 s53, 0
    s_cbranch_scc1 L_pf_other
    s_lshr_b32 s54, s52, 1
    s_mul_i32 s54, s54, 50
    v_add_u32 v3, s54, v2
    v_mul_u32_u24 v5, 9363, v3
    v_lshrrev_b32 v5, 16, v5
    v_mul_u32_u24 v6, 7, v5
    v_sub_u32 v6, v3, v6
    v_mul_u32_u24 v5, 7168, v5
    v_lshl_add_u32 v5, v6, 7, v5
    s_mul_i32 s54, s48, 896
    v_add_u32 v5, s54, v5
    v_cmp_gt_u32 vcc, 50, v2
    s_movk_i32 s54, 448
    v_cmp_gt_u32 s[44:45], s54, v3
    v_bfrev_b32 v7, 2
    s_lshl_b32 s54, s52, 3
    s_and_b64 vcc, vcc, s[44:45]
    v_lshrrev_b32 v3, 2, v2
    v_add_u32 v3, s54, v3
    v_lshlrev_b32 v6, 11, v3
    v_and_b32 v3, 3, v2
    v_lshl_add_u32 v6, v3, 7, v6
    v_cndmask_b32 v10, v7, v5, vcc
    v_cmp_gt_u32 vcc, 32, v2
    s_bitcmp1_b32 s52, 0
    s_nop 0
    v_cndmask_b32 v11, v7, v6, vcc
    s_waitcnt lgkmcnt(0)
    s_cselect_b64 s[24:25], s[6:7], s[8:9]
    s_mov_b64 s[20:21], s[4:5]
    buffer_load_dword v22, v11, s[20:23], 0 offen
    s_movk_i32 s58, 512
    buffer_load_dword v22, v11, s[20:23], s58 offen
    buffer_load_dword v20, v10, s[24:27], 0 offen
    s_mov_b32 s57, 458752
    buffer_load_dword v20, v10, s[24:27], s57 offen
    s_branch L_pf_go_on
L_p1:
    s_and_b32 s47, s49, 1
    s_lshr_b32 s52, s49, 1
    s_mul_i32 s54, s48, 7
    s_add_u32 s52, s52, s54
    s_cmp_lt_u32 s53, 4
    s_cbranch_scc1 L_front
    v_and_b32 v1, 3, v1
    s_lshl_b32 s54, s52, 7
    v_lshrrev_b32 v3, 3, v2
    v_and_b32 v4, 7, v2
    v_lshl_add_u32 v5, v1, 4, v3
    v_mul_u32_u24 v6, 7168, v5
    v_add_u32 v6, s54, v6
    v_and_b32 v7, 2, v3
    v_xor_b32 v7, v7, v4
    v_lshl_add_u32 v10, v7, 4, v6
    v_xor_b32 v11, 64, v10
    v_lshrrev_b32 v7, 1, v3
    v_xor_b32 v7, v7, v4
    s_lshl_b32 s54, s47, 6
    v_add_u32 v5, s54, v5
    v_lshlrev_b32 v5, 11, v5
    v_lshl_add_u32 v12, v7, 4, v5
    v_xor_b32 v13, 64, v12
    v_add_u32 v13, 0x4000, v13
    s_and_b32 s56, s53, 3
    s_lshl_b32 s56, s56, 11
    s_mov_b32 s30, 7340032
    s_mov_b32 s31, 0x20000
    v_mov_b32 v16, 155648
    v_lshl_add_u32 v14, v1, 2, v16
    v_mov_b32 v9, 0
    ds_write_b32 v14, v9
    ds_write_b32 v14, v9 offset:16
    ds_write_b32 v16, v9 offset:36
    v_mov_b32 v15, -1
    s_waitcnt lgkmcnt(0)
    s_mov_b64 s[20:21], s[4:5]
    s_mov_b64 s[24:25], s[6:7]
    s_mov_b64 s[28:29], s[8:9]
    s_add_u32 m0, s56, 0
    s_mov_b32 s57, 0
    buffer_load_dwordx4 v12, s[20:23], s57 offen  lds
    s_add_u32 m0, s56, 1024
    s_mov_b32 s57, 0
    buffer_load_dwordx4 v13, s[20:23], s57 offen  lds
    s_add_u32 m0, s56, 24576
    s_mov_b32 s57, 128
    buffer_load_dwordx4 v12, s[20:23], s57 offen  lds
    s_add_u32 m0, s56, 25600
    s_mov_b32 s57, 128
    buffer_load_dwordx4 v13, s[20:23], s57 offen  lds
    s_add_u32 m0, s56, 49152
    s_mov_b32 s57, 256
    buffer_load_dwordx4 v12, s[20:23], s57 offen  lds
    s_add_u32 m0, s56, 50176
    s_mov_b32 s57, 256
    buffer_load_dwordx4 v13, s[20:23], s57 offen  lds
    s_branch L_back_go_on
L_front:
    v_bfe_u32 v4, v2, 4, 1
    v_lshrrev_b32 v5, 5, v2
    v_bfe_u32 v6, v2, 2, 2
    v_lshrrev_b32 v7, 1, v6
    v_lshl_add_u32 v7, v4, 1, v7
    v_xor_b32 v7, v7, v1
    v_lshl_add_u32 v6, v5, 3, v6
    v_lshlrev_b32 v6, 7, v6
    v_lshl_add_u32 v6, v7, 5, v6
    v_lshl_add_u32 v6, v4, 13, v6
    v_and_b32 v7, 3, v2
    v_lshl_add_u32 v6, v7, 3, v6
    v_add_u32 v16, 0x2000, v6
    v_and_b32 v6, 31, v2
    v_bfe_u32 v7, v6, 1, 3
    v_xor_b32 v7, v7, v5
    v_lshlrev_b32 v6, 7, v6
    v_xor_b32 v8, 0, v7
    v_lshl_add_u32 v20, v8, 4, v6
    v_xor_b32 v8, 2, v7
    v_lshl_add_u32 v21, v8, 4, v6
    v_xor_b32 v8, 4, v7
    v_lshl_add_u32 v22, v8, 4, v6
    v_xor_b32 v8, 6, v7
    v_lshl_add_u32 v23, v8, 4, v6
    s_branch L_front_go_on
L_pf_go_on:
    s_cmp_lt_u32 s52, 14
    s_cselect_b64 s[44:45], s[16:17], s[12:13]
    s_cmp_lt_u32 s52, 12
    s_cselect_b64 s[44:45], s[10:11], s[44:45]
    s_cmp_lt_u32 s52, 8
    s_cselect_b64 s[44:45], s[8:9], s[44:45]
    s_cmp_lt_u32 s52, 4
    s_cselect_b64 s[44:45], s[6:7], s[44:45]
    s_and_b32 s54, s52, 3
    s_lshl_b32 s54, s54, 21
    s_cmp_lt_u32 s52, 14
    s_cselect_b32 s54, s54, 0
    s_load_dword s87, s[44:45], s54
    s_movk_i32 s88, 8192
    s_load_dword s59, s[16:17], s88
    s_load_dword s87, s[14:15], 0
    s_lshl_b32 s88, s48, 7
    s_add_u32 s88, s88, 12288
    s_load_dword s87, s[16:17], s88
    s_add_u32 s89, s88, 64
    s_load_dword s87, s[16:17], s89
    s_mov_b32 s57, 917504
    buffer_load_dword v20, v10, s[24:27], s57 offen
    s_mov_b32 s57, 1376256
    buffer_load_dword v20, v10, s[24:27], s57 offen
    s_movk_i32 s58, 1024
    buffer_load_dword v22, v11, s[20:23], s58 offen
    s_mov_b32 s57, 1835008
    buffer_load_dword v20, v10, s[24:27], s57 offen
    s_mov_b32 s57, 2293760
    buffer_load_dword v20, v10, s[24:27], s57 offen
    s_mov_b32 s57, 2752512
    buffer_load_dword v20, v10, s[24:27], s57 offen
    s_mov_b32 s57, 3211264
    buffer_load_dword v20, v10, s[24:27], s57 offen
    s_getreg_b32 s86, hwreg(HW_REG_XCC_ID, 0, 4)
    s_lshl_b32 s86, s86, 24
    s_lshl_b32 s89, s49, 2
    s_add_u32 s88, s88, s89
    v_mov_b32 v31, s88
    s_waitcnt lgkmcnt(0)
    v_mov_b32 v30, 0
    s_add_u32 s59, s59, 1
    s_bitset1_b32 s59, 31
    global_load_dword v12, v30, s[14:15] sc1
    s_movk_i32 s58, 1536
    buffer_load_dword v22, v11, s[20:23], s58 offen
    s_mov_b32 s57, 3670016
    buffer_load_dword v20, v10, s[24:27], s57 offen
    s_mov_b32 s57, 4128768
    buffer_load_dword v20, v10, s[24:27], s57 offen
    s_mov_b32 s57, 4587520
    buffer_load_dword v20, v10, s[24:27], s57 offen
    s_mov_b32 s57, 5046272
    buffer_load_dword v20, v10, s[24:27], s57 offen
    s_mov_b32 s57, 5505024
    buffer_load_dword v20, v10, s[24:27], s57 offen
    s_waitcnt vmcnt(6)
    v_cmp_eq_u32 vcc, 0, v12
    v_mov_b32 v30, s59
    v_mov_b32 v28, 155680
    v_cndmask_b32 v12, v12, v30, vcc
    ds_write_b32 v28, v12
    v_xor_b32 v30, s86, v12
    s_mov_b32 s57, 5963776
    buffer_load_dword v20, v10, s[24:27], s57 offen
    s_mov_b32 s57, 6422528
    buffer_load_dword v20, v10, s[24:27], s57 offen
    s_mov_b32 s57, 6881280
    buffer_load_dword v20, v10, s[24:27], s57 offen
    s_waitcnt vmcnt(5)
    global_store_dword v31, v30, s[16:17]
    s_lshl_b32 s54, s49, 3
    s_add_u32 s54, s54, s48
    s_lshl_b32 s57, s54, 13
    s_add_u32 s57, s57, 1048576
    v_lshl_add_u32 v3, v2, 4, s57
    v_add_u32 v8, 0x1000, v3
    s_lshl_b32 s54, s54, 7
    s_add_u32 s54, s54, 16384
    v_mov_b32 v13, s54
    v_mov_b32 v4, -1
    v_mov_b32 v5, -1
    v_mov_b32 v6, -1
    v_mov_b32 v7, -1
    s_cmp_lt_u32 s52, 14
    global_store_dwordx4 v3, v[4:7], s[16:17] offset:0 sc1
    global_store_dwordx4 v3, v[4:7], s[16:17] offset:1024 sc1
    global_store_dwordx4 v3, v[4:7], s[16:17] offset:2048 sc1
    global_store_dwordx4 v3, v[4:7], s[16:17] offset:3072 sc1
    global_store_dwordx4 v8, v[4:7], s[16:17] offset:0 sc1
    global_store_dwordx4 v8, v[4:7], s[16:17] offset:1024 sc1
    global_store_dwordx4 v8, v[4:7], s[16:17] offset:2048 sc1
    global_store_dwordx4 v8, v[4:7], s[16:17] offset:3072 sc1
    s_cbranch_scc0 L_pz_one
    v_subrev_u32 v3, 917504, v3
    v_subrev_u32 v8, 917504, v8
    global_store_dwordx4 v3, v[4:7], s[16:17] offset:0 sc1
    global_store_dwordx4 v3, v[4:7], s[16:17] offset:1024 sc1
    global_store_dwordx4 v3, v[4:7], s[16:17] offset:2048 sc1
    global_store_dwordx4 v3, v[4:7], s[16:17] offset:3072 sc1
    global_store_dwordx4 v8, v[4:7], s[16:17] offset:0 sc1
    global_store_dwordx4 v8, v[4:7], s[16:17] offset:1024 sc1
    global_store_dwordx4 v8, v[4:7], s[16:17] offset:2048 sc1
    global_store_dwordx4 v8, v[4:7], s[16:17] offset:3072 sc1
L_pz_one:
    s_lshl_b32 s54, s52, 6
    v_add_u32 v3, s54, v2
    v_min_u32 v3, 895, v3
    s_mul_i32 s54, s48, 114688
    s_add_u32 s54, s54, 65536
    v_lshl_add_u32 v3, v3, 7, s54
    global_load_dword v24, v3, s[16:17]
    s_waitcnt lgkmcnt(0)
    s_barrier
    s_waitcnt vmcnt(1)
    global_store_dword v13, v12, s[16:17] sc1
    s_barrier
    s_branch L_pf_front
L_pf_other:
    s_cmp_ge_u32 s53, 4
    s_cbranch_scc1 L_back_pf
    s_waitcnt lgkmcnt(0)
    s_barrier
    s_barrier
L_pf_front:
    s_mov_b32 s50, 1
    s_cmp_ge_u32 s52, 3
    s_addc_u32 s51, s52, 0
    s_cmp_ge_u32 s52, 10
    s_addc_u32 s51, s51, 0
    s_mov_b32 s46, 0
    s_cmp_ge_u32 s52, 14
    s_cbranch_scc0 L_pf_role_f
    s_and_b32 s50, s52, 1
    s_mul_i32 s46, s50, 7
    s_cmp_ge_u32 s52, 16
    s_cselect_b32 s51, 11, 3
L_pf_role_f:
    s_getreg_b32 s86, hwreg(HW_REG_XCC_ID, 0, 4)
    s_lshl_b32 s86, s86, 24
    s_lshl_b32 s55, s53, 10
    s_lshl_b32 s82, s46, 13
    s_sub_u32 s83, 0, s82
    s_mul_i32 s54, s48, 112
    s_lshl_b32 s57, s50, 2
    s_add_u32 s54, s54, s57
    v_add_u32 v6, s54, v1
    v_lshlrev_b32 v6, 10, v6
    v_lshl_add_u32 v19, v2, 4, v6
    v_add_u32 v19, 65536, v19
    s_lshl_b32 s54, s48, 1
    s_add_u32 s54, s54, s50
    s_lshl_b32 s54, s54, 7
    s_add_u32 s54, s54, 0
    v_min_u32 v6, 27, v2
    v_lshl_add_u32 v18, v6, 2, s54
    s_lshl_b32 s54, s48, 7
    s_add_u32 s54, s54, 12288
    v_and_b32 v6, 31, v2
    v_lshl_add_u32 v29, v6, 2, s54
    v_and_b32 v7, 1, v6
    v_lshlrev_b32 v7, 7, v7
    v_lshrrev_b32 v8, 1, v6
    v_lshl_add_u32 v7, v8, 4, v7
    v_cmp_gt_u32 vcc, 14, v6
    s_lshl_b32 s54, s48, 8
    s_add_u32 s54, s54, 0
    v_add_u32 v7, s54, v7
    v_cndmask_b32 v29, v29, v7, vcc
    s_cmp_lt_u32 s49, 14
    s_cselect_b32 s54, 14, 0
    s_add_u32 s54, s54, s49
    s_lshl_b32 s54, s54, 10
    s_add_u32 s91, s54, 16384
    s_mov_b32 s38, 268435456
    s_mov_b32 s39, 0x20000
    s_mov_b64 s[36:37], s[16:17]
    v_mov_b32 v5, 155680
    ds_read_b32 v12, v5
    s_mov_b32 s90, 0
    v_bfrev_b32 v14, 2
    v_bfrev_b32 v15, 2
    s_waitcnt lgkmcnt(0)
    v_xor_b32 v3, s86, v12
    s_lshl_b32 s54, s2, 3
    s_add_u32 s54, s54, s53
    s_cmp_eq_u32 s54, 2043
    s_cbranch_scc0 L_upd_done
    v_mov_b32 v26, 0
    v_mov_b32 v27, 8192
    s_mov_b64 exec, 1
    global_store_dword v26, v12, s[14:15] sc1
    s_waitcnt vmcnt(0)
    global_store_dword v27, v12, s[16:17] sc1
    s_mov_b64 exec, -1
L_upd_done:
    s_cmp_lg_u32 s53, 0
    s_cbranch_scc1 L_pzp_done
    v_and_b32 v22, 7, v2
    v_lshl_add_u32 v22, v22, 7, s91
    s_mov_b32 s80, 0
L_pzp:
    buffer_load_dword v21, v22, s[36:39], 0 offen sc1
    s_add_u32 s80, s80, 1
    s_cmp_ge_u32 s80, 2
    s_waitcnt vmcnt(0)
    v_cmp_ne_u32 vcc, v12, v21
    s_cbranch_vccz L_pzp_done
    s_cbranch_scc1 L_pzp_done
    s_sleep 12
    s_branch L_pzp
L_pzp_done:
    s_barrier
    s_branch L_hload
L_back_pf:
    v_and_b32 v1, 3, v1
    v_mov_b32 v16, 155648
    v_lshl_add_u32 v14, v1, 2, v16
    v_mov_b32 v9, 0
    ds_write_b32 v14, v9
    ds_write_b32 v14, v9 offset:16
    ds_write_b32 v16, v9 offset:36
    v_mov_b32 v15, -1
    s_mov_b32 s50, 1
    s_cmp_ge_u32 s52, 3
    s_addc_u32 s51, s52, 0
    s_cmp_ge_u32 s52, 10
    s_addc_u32 s51, s51, 0
    s_mov_b32 s46, 0
    s_cmp_ge_u32 s52, 14
    s_cbranch_scc0 L_pf_role_b
    s_and_b32 s50, s52, 1
    s_mul_i32 s46, s50, 7
    s_cmp_ge_u32 s52, 16
    s_cselect_b32 s51, 11, 3
L_pf_role_b:
    s_waitcnt lgkmcnt(0)
    s_mov_b64 s[32:33], s[10:11]
    s_mov_b32 s34, 7340032
    s_mov_b32 s35, 0x20000
    s_mov_b64 s[36:37], s[16:17]
    s_mov_b32 s38, 268435456
    s_mov_b32 s39, 0x20000
    s_mov_b64 s[40:41], s[12:13]
    s_mov_b32 s42, 262144
    s_mov_b32 s43, 0x20000
    s_and_b32 s55, s53, 3
    s_lshl_b32 s55, s55, 10
    s_lshl_b32 s84, s46, 16
    s_sub_u32 s85, 0, s84
    v_lshrrev_b32 v3, 3, v2
    v_and_b32 v4, 7, v2
    v_and_b32 v6, 6, v3
    v_xor_b32 v4, v4, v6
    v_lshl_add_u32 v3, v1, 3, v3
    s_mul_i32 s60, s48, 448
    v_add_u32 v3, s60, v3
    v_lshlrev_b32 v3, 11, v3
    s_lshl_b32 s60, s51, 7
    v_add_u32 v3, s60, v3
    v_lshl_add_u32 v17, v4, 4, v3
    v_lshlrev_b32 v3, 10, v1
    v_lshl_add_u32 v19, v2, 4, v3
    v_lshrrev_b32 v3, 4, v2
    v_bfe_u32 v4, v2, 2, 2
    v_and_b32 v7, 1, v3
    v_lshrrev_b32 v6, 1, v3
    v_lshlrev_b32 v6, 4, v6
    v_lshl_add_u32 v6, v7, 2, v6
    v_add_u32 v6, v6, v4
    v_lshlrev_b32 v6, 7, v6
    v_and_b32 v8, 3, v2
    v_lshl_add_u32 v6, v8, 3, v6
    v_add_u32 v6, 98304, v6
    v_lshrrev_b32 v4, 1, v4
    v_lshl_add_u32 v4, v7, 1, v4
    v_xor_b32 v7, 0, v4
    v_lshl_add_u32 v20, v7, 5, v6
    v_xor_b32 v7, 1, v4
    v_lshl_add_u32 v21, v7, 5, v6
    v_xor_b32 v7, 2, v4
    v_lshl_add_u32 v22, v7, 5, v6
    v_xor_b32 v7, 3, v4
    v_lshl_add_u32 v23, v7, 5, v6
    v_bfe_u32 v4, v2, 3, 1
    v_lshl_add_u32 v6, v1, 1, v4
    s_lshl_b32 s60, s49, 3
    v_add_u32 v6, s60, v6
    v_lshlrev_b32 v6, 3, v6
    v_add_u32 v6, s48, v6
    v_lshlrev_b32 v6, 10, v6
    v_lshl_add_u32 v6, v3, 7, v6
    v_and_b32 v7, 7, v2
    v_lshl_add_u32 v6, v7, 4, v6
    v_add_u32 v8, 1048576, v6
    s_cmp_lt_u32 s49, 14
    s_cselect_b32 s61, 14*8, 0
    s_add_u32 s61, s61, s60
    s_lshl_b32 s61, s61, 7
    s_add_u32 s61, s61, 16384
    v_lshl_add_u32 v18, v7, 7, s61
    s_add_u32 s60, s60, s48
    s_lshl_b32 s60, s60, 13
    s_add_u32 s60, s60, 1048576
    v_and_b32 v6, 15, v2
    v_lshl_add_u32 v6, v1, 4, v6
    v_lshlrev_b32 v6, 4, v6
    v_lshl_add_u32 v6, v3, 11, v6
    v_add_u32 v6, s60, v6
    s_lshl_b32 s60, s50, 6
    s_lshl_b32 s61, s48, 3
    s_add_u32 s60, s60, s61
    v_add_u32 v7, s60, v7
    v_lshlrev_b32 v7, 11, v7
    v_lshl_add_u32 v7, v4, 3, v7
    v_and_b32 v4, 1, v1
    v_lshl_add_u32 v7, v4, 4, v7
    v_lshrrev_b32 v4, 1, v1
    v_lshl_add_u32 v7, v4, 6, v7
    v_and_b32 v4, 1, v3
    v_lshl_add_u32 v7, v4, 2, v7
    v_lshrrev_b32 v4, 1, v3
    v_lshl_add_u32 v7, v4, 5, v7
    s_lshl_b32 s60, s51, 7
    v_add_u32 v7, s60, v7
    s_barrier
    s_add_u32 m0, s55, 98304
    s_add_u32 s57, s84, 0
    buffer_load_dwordx4 v17, s[32:35], s57 offen lds
    s_add_u32 m0, s55, 102400
    s_add_u32 s57, s84, 65536
    buffer_load_dwordx4 v17, s[32:35], s57 offen lds
    s_add_u32 m0, s55, 106496
    s_add_u32 s57, s84, 131072
    buffer_load_dwordx4 v17, s[32:35], s57 offen lds
    s_add_u32 m0, s55, 110592
    s_add_u32 s57, s84, 196608
    buffer_load_dwordx4 v17, s[32:35], s57 offen lds
    s_add_u32 m0, s55, 114688
    s_add_u32 s57, s84, 262144
    buffer_load_dwordx4 v17, s[32:35], s57 offen lds
    s_barrier
    s_add_u32 m0, s55, 118784
    s_add_u32 s57, s84, 327680
    buffer_load_dwordx4 v17, s[32:35], s57 offen lds
    s_add_u32 m0, s55, 122880
    s_add_u32 s57, s84, 393216
    buffer_load_dwordx4 v17, s[32:35], s57 offen lds
    s_add_u32 m0, s55, 126976
    s_add_u32 s57, s85, 458752
    buffer_load_dwordx4 v17, s[32:35], s57 offen lds
    s_add_u32 m0, s55, 131072
    s_add_u32 s57, s85, 524288
    buffer_load_dwordx4 v17, s[32:35], s57 offen lds
    s_add_u32 m0, s55, 135168
    s_add_u32 s57, s85, 589824
    buffer_load_dwordx4 v17, s[32:35], s57 offen lds
    s_add_u32 m0, s55, 139264
    s_add_u32 s57, s85, 655360
    buffer_load_dwordx4 v17, s[32:35], s57 offen lds
    s_add_u32 m0, s55, 143360
    s_add_u32 s57, s85, 720896
    buffer_load_dwordx4 v17, s[32:35], s57 offen lds
    s_add_u32 m0, s55, 147456
    s_add_u32 s57, s85, 786432
    buffer_load_dwordx4 v17, s[32:35], s57 offen lds
    s_add_u32 m0, s55, 151552
    s_add_u32 s57, s85, 851968
    buffer_load_dwordx4 v17, s[32:35], s57 offen lds
    ds_read_b32 v5, v16 offset:32
    s_branch L_p2
L_back_go_on:
    s_add_u32 m0, s56, 8192
    s_mov_b32 s57, 0
    buffer_load_dwordx4 v10, s[24:27], s57 offen  lds
    s_add_u32 m0, s56, 9216
    s_mov_b32 s57, 57344
    buffer_load_dwordx4 v10, s[24:27], s57 offen  lds
    s_add_u32 m0, s56, 16384
    s_mov_b32 s57, 0
    buffer_load_dwordx4 v11, s[28:31], s57 offen  lds
    s_add_u32 m0, s56, 17408
    s_mov_b32 s57, 57344
    buffer_load_dwordx4 v11, s[28:31], s57 offen  lds
    s_add_u32 m0, s56, 32768
    s_mov_b32 s57, 458752
    buffer_load_dwordx4 v10, s[24:27], s57 offen  lds
    s_add_u32 m0, s56, 33792
    s_mov_b32 s57, 516096
    buffer_load_dwordx4 v10, s[24:27], s57 offen  lds
    s_add_u32 m0, s56, 40960
    s_mov_b32 s57, 458752
    buffer_load_dwordx4 v11, s[28:31], s57 offen  lds
    s_add_u32 m0, s56, 41984
    s_mov_b32 s57, 516096
    buffer_load_dwordx4 v11, s[28:31], s57 offen  lds
    s_movk_i32 s88, 8192
    s_load_dword s59, s[16:17], s88
    s_load_dword s87, s[14:15], 0
    s_mov_b32 s50, 0
    s_cmp_ge_u32 s49, 3
    s_addc_u32 s51, s49, 0
    s_cmp_ge_u32 s49, 10
    s_addc_u32 s51, s51, 0
    s_mov_b32 s46, 0
    s_mov_b64 s[32:33], s[10:11]
    s_mov_b32 s34, 7340032
    s_mov_b32 s35, 0x20000
    s_mov_b64 s[36:37], s[16:17]
    s_mov_b32 s38, 268435456
    s_mov_b32 s39, 0x20000
    s_mov_b64 s[40:41], s[12:13]
    s_mov_b32 s42, 262144
    s_mov_b32 s43, 0x20000
    s_and_b32 s55, s53, 3
    s_lshl_b32 s55, s55, 10
    s_lshl_b32 s84, s46, 16
    s_sub_u32 s85, 0, s84
    v_lshrrev_b32 v3, 3, v2
    v_and_b32 v4, 7, v2
    v_and_b32 v6, 6, v3
    v_xor_b32 v4, v4, v6
    v_lshl_add_u32 v3, v1, 3, v3
    s_mul_i32 s60, s48, 448
    v_add_u32 v3, s60, v3
    v_lshlrev_b32 v3, 11, v3
    s_lshl_b32 s60, s51, 7
    v_add_u32 v3, s60, v3
    v_lshl_add_u32 v17, v4, 4, v3
    v_lshlrev_b32 v3, 10, v1
    v_lshl_add_u32 v19, v2, 4, v3
    v_lshrrev_b32 v3, 4, v2
    v_bfe_u32 v4, v2, 2, 2
    v_and_b32 v7, 1, v3
    v_lshrrev_b32 v6, 1, v3
    v_lshlrev_b32 v6, 4, v6
    v_lshl_add_u32 v6, v7, 2, v6
    v_add_u32 v6, v6, v4
    v_lshlrev_b32 v6, 7, v6
    v_and_b32 v8, 3, v2
    v_lshl_add_u32 v6, v8, 3, v6
    v_add_u32 v6, 98304, v6
    v_lshrrev_b32 v4, 1, v4
    v_lshl_add_u32 v4, v7, 1, v4
    v_xor_b32 v7, 0, v4
    v_lshl_add_u32 v20, v7, 5, v6
    v_xor_b32 v7, 1, v4
    v_lshl_add_u32 v21, v7, 5, v6
    v_xor_b32 v7, 2, v4
    v_lshl_add_u32 v22, v7, 5, v6
    v_xor_b32 v7, 3, v4
    v_lshl_add_u32 v23, v7, 5, v6
    v_bfe_u32 v4, v2, 3, 1
    v_lshl_add_u32 v6, v1, 1, v4
    s_lshl_b32 s60, s49, 3
    v_add_u32 v6, s60, v6
    v_lshlrev_b32 v6, 3, v6
    v_add_u32 v6, s48, v6
    v_lshlrev_b32 v6, 10, v6
    v_lshl_add_u32 v6, v3, 7, v6
    v_and_b32 v7, 7, v2
    v_lshl_add_u32 v6, v7, 4, v6
    v_add_u32 v8, 1048576, v6
    s_cmp_lt_u32 s49, 14
    s_cselect_b32 s61, 14*8, 0
    s_add_u32 s61, s61, s60
    s_lshl_b32 s61, s61, 7
    s_add_u32 s61, s61, 16384
    v_lshl_add_u32 v18, v7, 7, s61
    s_add_u32 s60, s60, s48
    s_lshl_b32 s60, s60, 13
    s_add_u32 s60, s60, 1048576
    v_and_b32 v6, 15, v2
    v_lshl_add_u32 v6, v1, 4, v6
    v_lshlrev_b32 v6, 4, v6
    v_lshl_add_u32 v6, v3, 11, v6
    v_add_u32 v6, s60, v6
    s_lshl_b32 s60, s50, 6
    s_lshl_b32 s61, s48, 3
    s_add_u32 s60, s60, s61
    v_add_u32 v7, s60, v7
    v_lshlrev_b32 v7, 11, v7
    v_lshl_add_u32 v7, v4, 3, v7
    v_and_b32 v4, 1, v1
    v_lshl_add_u32 v7, v4, 4, v7
    v_lshrrev_b32 v4, 1, v1
    v_lshl_add_u32 v7, v4, 6, v7
    v_and_b32 v4, 1, v3
    v_lshl_add_u32 v7, v4, 2, v7
    v_lshrrev_b32 v4, 1, v3
    v_lshl_add_u32 v7, v4, 5, v7
    s_lshl_b32 s60, s51, 7
    v_add_u32 v7, s60, v7
    s_add_u32 m0, s56, 57344
    s_mov_b32 s57, 917504
    buffer_load_dwordx4 v10, s[24:27], s57 offen  lds
    s_add_u32 m0, s56, 58368
    s_mov_b32 s57, 974848
    buffer_load_dwordx4 v10, s[24:27], s57 offen  lds
    s_add_u32 m0, s56, 65536
    s_mov_b32 s57, 917504
    buffer_load_dwordx4 v11, s[28:31], s57 offen  lds
    s_add_u32 m0, s56, 66560
    s_mov_b32 s57, 974848
    buffer_load_dwordx4 v11, s[28:31], s57 offen  lds
    s_waitcnt vmcnt(8)
    s_barrier
    s_add_u32 m0, s56, 73728
    s_mov_b32 s57, 384
    buffer_load_dwordx4 v12, s[20:23], s57 offen  lds
    s_add_u32 m0, s56, 74752
    s_mov_b32 s57, 384
    buffer_load_dwordx4 v13, s[20:23], s57 offen  lds
    s_add_u32 m0, s56, 81920
    s_mov_b32 s57, 1376256
    buffer_load_dwordx4 v10, s[24:27], s57 offen  lds
    s_add_u32 m0, s56, 82944
    s_mov_b32 s57, 1433600
    buffer_load_dwordx4 v10, s[24:27], s57 offen  lds
    s_add_u32 m0, s56, 90112
    s_mov_b32 s57, 1376256
    buffer_load_dwordx4 v11, s[28:31], s57 offen  lds
    s_add_u32 m0, s56, 91136
    s_mov_b32 s57, 1433600
    buffer_load_dwordx4 v11, s[28:31], s57 offen  lds
    s_waitcnt vmcnt(10)
    s_barrier
    s_add_u32 m0, s56, 0
    s_mov_b32 s57, 512
    buffer_load_dwordx4 v12, s[20:23], s57 offen  lds
    s_add_u32 m0, s56, 1024
    s_mov_b32 s57, 512
    buffer_load_dwordx4 v13, s[20:23], s57 offen  lds
    s_add_u32 m0, s56, 8192
    s_mov_b32 s57, 1835008
    buffer_load_dwordx4 v10, s[24:27], s57 offen  lds
    s_add_u32 m0, s56, 9216
    s_mov_b32 s57, 1892352
    buffer_load_dwordx4 v10, s[24:27], s57 offen  lds
    s_add_u32 m0, s56, 16384
    s_mov_b32 s57, 1835008
    buffer_load_dwordx4 v11, s[28:31], s57 offen  lds
    s_add_u32 m0, s56, 17408
    s_mov_b32 s57, 1892352
    buffer_load_dwordx4 v11, s[28:31], s57 offen  lds
    s_waitcnt vmcnt(12)
    s_barrier
    s_add_u32 m0, s56, 24576
    s_mov_b32 s57, 640
    buffer_load_dwordx4 v12, s[20:23], s57 offen  lds
    s_add_u32 m0, s56, 25600
    s_mov_b32 s57, 640
    buffer_load_dwordx4 v13, s[20:23], s57 offen  lds
    s_add_u32 m0, s56, 32768
    s_mov_b32 s57, 2293760
    buffer_load_dwordx4 v10, s[24:27], s57 offen  lds
    s_add_u32 m0, s56, 33792
    s_mov_b32 s57, 2351104
    buffer_load_dwordx4 v10, s[24:27], s57 offen  lds
    s_add_u32 m0, s56, 40960
    s_mov_b32 s57, 2293760
    buffer_load_dwordx4 v11, s[28:31], s57 offen  lds
    s_add_u32 m0, s56, 41984
    s_mov_b32 s57, 2351104
    buffer_load_dwordx4 v11, s[28:31], s57 offen  lds
    s_waitcnt vmcnt(12)
    s_barrier
    s_add_u32 m0, s56, 49152
    s_mov_b32 s57, 768
    buffer_load_dwordx4 v12, s[20:23], s57 offen  lds
    s_add_u32 m0, s56, 50176
    s_mov_b32 s57, 768
    buffer_load_dwordx4 v13, s[20:23], s57 offen  lds
    s_add_u32 m0, s56, 57344
    s_mov_b32 s57, 2752512
    buffer_load_dwordx4 v10, s[24:27], s57 offen  lds
    s_add_u32 m0, s56, 58368
    s_mov_b32 s57, 2809856
    buffer_load_dwordx4 v10, s[24:27], s57 offen  lds
    s_add_u32 m0, s56, 65536
    s_mov_b32 s57, 2752512
    buffer_load_dwordx4 v11, s[28:31], s57 offen  lds
    s_add_u32 m0, s56, 66560
    s_mov_b32 s57, 2809856
    buffer_load_dwordx4 v11, s[28:31], s57 offen  lds
    s_waitcnt vmcnt(12)
    s_barrier
    s_add_u32 m0, s56, 73728
    s_mov_b32 s57, 896
    buffer_load_dwordx4 v12, s[20:23], s57 offen  lds
    s_add_u32 m0, s56, 74752
    s_mov_b32 s57, 896
    buffer_load_dwordx4 v13, s[20:23], s57 offen  lds
    s_add_u32 m0, s56, 81920
    s_mov_b32 s57, 3211264
    buffer_load_dwordx4 v10, s[24:27], s57 offen  lds
    s_add_u32 m0, s56, 82944
    s_mov_b32 s57, 3268608
    buffer_load_dwordx4 v10, s[24:27], s57 offen  lds
    s_add_u32 m0, s56, 90112
    s_mov_b32 s57, 3211264
    buffer_load_dwordx4 v11, s[28:31], s57 offen  lds
    s_add_u32 m0, s56, 91136
    s_mov_b32 s57, 3268608
    buffer_load_dwordx4 v11, s[28:31], s57 offen  lds
    s_waitcnt vmcnt(12)
    s_barrier
    s_add_u32 m0, s56, 0
    s_mov_b32 s57, 1024
    buffer_load_dwordx4 v12, s[20:23], s57 offen  lds
    s_add_u32 m0, s56, 1024
    s_mov_b32 s57, 1024
    buffer_load_dwordx4 v13, s[20:23], s57 offen  lds
    s_add_u32 m0, s56, 8192
    s_mov_b32 s57, 3670016
    buffer_load_dwordx4 v10, s[24:27], s57 offen  lds
    s_add_u32 m0, s56, 9216
    s_mov_b32 s57, 3727360
    buffer_load_dwordx4 v10, s[24:27], s57 offen  lds
    s_add_u32 m0, s56, 16384
    s_mov_b32 s57, 3670016
    buffer_load_dwordx4 v11, s[28:31], s57 offen  lds
    s_add_u32 m0, s56, 17408
    s_mov_b32 s57, 3727360
    buffer_load_dwordx4 v11, s[28:31], s57 offen  lds
    s_waitcnt lgkmcnt(0)
    v_mov_b32 v30, 0
    s_add_u32 s59, s59, 1
    s_bitset1_b32 s59, 31
    global_load_dword v5, v30, s[14:15] sc1
    s_waitcnt vmcnt(13)
    s_barrier
    s_add_u32 m0, s56, 24576
    s_mov_b32 s57, 1152
    buffer_load_dwordx4 v12, s[20:23], s57 offen  lds
    s_add_u32 m0, s56, 25600
    s_mov_b32 s57, 1152
    buffer_load_dwordx4 v13, s[20:23], s57 offen  lds
    s_add_u32 m0, s56, 32768
    s_mov_b32 s57, 4128768
    buffer_load_dwordx4 v10, s[24:27], s57 offen  lds
    s_add_u32 m0, s56, 33792
    s_mov_b32 s57, 4186112
    buffer_load_dwordx4 v10, s[24:27], s57 offen  lds
    s_add_u32 m0, s56, 40960
    s_mov_b32 s57, 4128768
    buffer_load_dwordx4 v11, s[28:31], s57 offen  lds
    s_add_u32 m0, s56, 41984
    s_mov_b32 s57, 4186112
    buffer_load_dwordx4 v11, s[28:31], s57 offen  lds
    s_waitcnt vmcnt(13)
    s_barrier
    s_add_u32 m0, s56, 49152
    s_mov_b32 s57, 1280
    buffer_load_dwordx4 v12, s[20:23], s57 offen  lds
    s_add_u32 m0, s56, 50176
    s_mov_b32 s57, 1280
    buffer_load_dwordx4 v13, s[20:23], s57 offen  lds
    s_add_u32 m0, s56, 57344
    s_mov_b32 s57, 4587520
    buffer_load_dwordx4 v10, s[24:27], s57 offen  lds
    s_add_u32 m0, s56, 58368
    s_mov_b32 s57, 4644864
    buffer_load_dwordx4 v10, s[24:27], s57 offen  lds
    s_add_u32 m0, s56, 65536
    s_mov_b32 s57, 4587520
    buffer_load_dwordx4 v11, s[28:31], s57 offen  lds
    s_add_u32 m0, s56, 66560
    s_mov_b32 s57, 4644864
    buffer_load_dwordx4 v11, s[28:31], s57 offen  lds
    s_waitcnt vmcnt(13)
    s_barrier
    s_add_u32 m0, s56, 73728
    s_mov_b32 s57, 1408
    buffer_load_dwordx4 v12, s[20:23], s57 offen  lds
    s_add_u32 m0, s56, 74752
    s_mov_b32 s57, 1408
    buffer_load_dwordx4 v13, s[20:23], s57 offen  lds
    s_add_u32 m0, s56, 81920
    s_mov_b32 s57, 5046272
    buffer_load_dwordx4 v10, s[24:27], s57 offen  lds
    s_add_u32 m0, s56, 82944
    s_mov_b32 s57, 5103616
    buffer_load_dwordx4 v10, s[24:27], s57 offen  lds
    s_add_u32 m0, s56, 90112
    s_mov_b32 s57, 5046272
    buffer_load_dwordx4 v11, s[28:31], s57 offen  lds
    s_add_u32 m0, s56, 91136
    s_mov_b32 s57, 5103616
    buffer_load_dwordx4 v11, s[28:31], s57 offen  lds
    s_waitcnt vmcnt(12)
    s_barrier
    v_cmp_eq_u32 vcc, 0, v5
    v_mov_b32 v30, s59
    s_nop 0
    v_cndmask_b32 v5, v5, v30, vcc
    s_add_u32 m0, s56, 0
    s_mov_b32 s57, 1536
    buffer_load_dwordx4 v12, s[20:23], s57 offen  lds
    s_add_u32 m0, s56, 1024
    s_mov_b32 s57, 1536
    buffer_load_dwordx4 v13, s[20:23], s57 offen  lds
    s_add_u32 m0, s56, 8192
    s_mov_b32 s57, 5505024
    buffer_load_dwordx4 v10, s[24:27], s57 offen  lds
    s_add_u32 m0, s56, 9216
    s_mov_b32 s57, 5562368
    buffer_load_dwordx4 v10, s[24:27], s57 offen  lds
    s_add_u32 m0, s56, 16384
    s_mov_b32 s57, 5505024
    buffer_load_dwordx4 v11, s[28:31], s57 offen  lds
    s_add_u32 m0, s56, 17408
    s_mov_b32 s57, 5562368
    buffer_load_dwordx4 v11, s[28:31], s57 offen  lds
    s_waitcnt vmcnt(12)
    s_barrier
    s_add_u32 m0, s56, 24576
    s_mov_b32 s57, 1664
    buffer_load_dwordx4 v12, s[20:23], s57 offen  lds
    s_add_u32 m0, s56, 25600
    s_mov_b32 s57, 1664
    buffer_load_dwordx4 v13, s[20:23], s57 offen  lds
    s_add_u32 m0, s56, 32768
    s_mov_b32 s57, 5963776
    buffer_load_dwordx4 v10, s[24:27], s57 offen  lds
    s_add_u32 m0, s56, 33792
    s_mov_b32 s57, 6021120
    buffer_load_dwordx4 v10, s[24:27], s57 offen  lds
    s_add_u32 m0, s56, 40960
    s_mov_b32 s57, 5963776
    buffer_load_dwordx4 v11, s[28:31], s57 offen  lds
    s_add_u32 m0, s56, 41984
    s_mov_b32 s57, 6021120
    buffer_load_dwordx4 v11, s[28:31], s57 offen  lds
    s_waitcnt vmcnt(12)
    s_barrier
    s_add_u32 m0, s56, 49152
    s_mov_b32 s57, 1792
    buffer_load_dwordx4 v12, s[20:23], s57 offen  lds
    s_add_u32 m0, s56, 50176
    s_mov_b32 s57, 1792
    buffer_load_dwordx4 v13, s[20:23], s57 offen  lds
    s_add_u32 m0, s56, 57344
    s_mov_b32 s57, 6422528
    buffer_load_dwordx4 v10, s[24:27], s57 offen  lds
    s_add_u32 m0, s56, 58368
    s_mov_b32 s57, 6479872
    buffer_load_dwordx4 v10, s[24:27], s57 offen  lds
    s_add_u32 m0, s56, 65536
    s_mov_b32 s57, 6422528
    buffer_load_dwordx4 v11, s[28:31], s57 offen  lds
    s_add_u32 m0, s56, 66560
    s_mov_b32 s57, 6479872
    buffer_load_dwordx4 v11, s[28:31], s57 offen  lds
    s_waitcnt vmcnt(12)
    s_barrier
    s_add_u32 m0, s56, 73728
    s_mov_b32 s57, 1920
    buffer_load_dwordx4 v12, s[20:23], s57 offen  lds
    s_add_u32 m0, s56, 74752
    s_mov_b32 s57, 1920
    buffer_load_dwordx4 v13, s[20:23], s57 offen  lds
    s_add_u32 m0, s56, 81920
    s_mov_b32 s57, 6881280
    buffer_load_dwordx4 v10, s[24:27], s57 offen  lds
    s_add_u32 m0, s56, 82944
    s_mov_b32 s57, 6938624
    buffer_load_dwordx4 v10, s[24:27], s57 offen  lds
    s_add_u32 m0, s56, 90112
    s_mov_b32 s57, 6881280
    buffer_load_dwordx4 v11, s[28:31], s57 offen  lds
    s_add_u32 m0, s56, 91136
    s_mov_b32 s57, 6938624
    buffer_load_dwordx4 v11, s[28:31], s57 offen  lds
    s_waitcnt vmcnt(12)
    s_barrier
    s_add_u32 m0, s55, 98304
    s_add_u32 s57, s84, 0
    buffer_load_dwordx4 v17, s[32:35], s57 offen lds
    s_add_u32 m0, s55, 102400
    s_add_u32 s57, s84, 65536
    buffer_load_dwordx4 v17, s[32:35], s57 offen lds
    s_add_u32 m0, s55, 106496
    s_add_u32 s57, s84, 131072
    buffer_load_dwordx4 v17, s[32:35], s57 offen lds
    s_waitcnt vmcnt(9)
    s_barrier
    s_add_u32 m0, s55, 110592
    s_add_u32 s57, s84, 196608
    buffer_load_dwordx4 v17, s[32:35], s57 offen lds
    s_add_u32 m0, s55, 114688
    s_add_u32 s57, s84, 262144
    buffer_load_dwordx4 v17, s[32:35], s57 offen lds
    s_add_u32 m0, s55, 118784
    s_add_u32 s57, s84, 327680
    buffer_load_dwordx4 v17, s[32:35], s57 offen lds
    s_add_u32 m0, s55, 122880
    s_add_u32 s57, s84, 393216
    buffer_load_dwordx4 v17, s[32:35], s57 offen lds
    s_add_u32 m0, s55, 126976
    s_add_u32 s57, s85, 458752
    buffer_load_dwordx4 v17, s[32:35], s57 offen lds
    s_waitcnt vmcnt(8)
    s_barrier
    s_add_u32 m0, s55, 131072
    s_add_u32 s57, s85, 524288
    buffer_load_dwordx4 v17, s[32:35], s57 offen lds
    s_add_u32 m0, s55, 135168
    s_add_u32 s57, s85, 589824
    buffer_load_dwordx4 v17, s[32:35], s57 offen lds
    s_add_u32 m0, s55, 139264
    s_add_u32 s57, s85, 655360
    buffer_load_dwordx4 v17, s[32:35], s57 offen lds
    s_waitcnt vmcnt(5)
L_p2:
    s_waitcnt vmcnt(8)
    ds_write_b32 v14, v15 offset:0
L_sy0:
    ds_read_b128 v[40:43], v16 offset:0
    s_waitcnt lgkmcnt(0)
    v_and_b32 v40, v40, v41
    v_and_b32 v42, v42, v43
    v_and_b32 v40, v40, v42
    v_cmp_eq_u32 vcc, 0, v40
    s_cbranch_vccnz L_sy0
    ds_read_b64_tr_b16 a[0:1], v20 offset:0
    ds_read_b64_tr_b16 a[2:3], v20 offset:1024
    ds_read_b64_tr_b16 a[4:5], v21 offset:0
    ds_read_b64_tr_b16 a[6:7], v21 offset:1024
    ds_read_b64_tr_b16 a[8:9], v22 offset:0
    ds_read_b64_tr_b16 a[10:11], v22 offset:1024
    ds_read_b64_tr_b16 a[12:13], v23 offset:0
    ds_read_b64_tr_b16 a[14:15], v23 offset:1024
    s_waitcnt lgkmcnt(6)
    ds_read_b64_tr_b16 a[16:17], v20 offset:4096
    ds_read_b64_tr_b16 a[18:19], v20 offset:5120
    ds_read_b64_tr_b16 a[20:21], v21 offset:4096
    ds_read_b64_tr_b16 a[22:23], v21 offset:5120
    ds_read_b64_tr_b16 a[24:25], v22 offset:4096
    ds_read_b64_tr_b16 a[26:27], v22 offset:5120
    ds_read_b64_tr_b16 a[28:29], v23 offset:4096
    ds_read_b64_tr_b16 a[30:31], v23 offset:5120
    s_waitcnt lgkmcnt(6)
    ds_read_b64_tr_b16 a[32:33], v20 offset:8192
    ds_read_b64_tr_b16 a[34:35], v20 offset:9216
    ds_read_b64_tr_b16 a[36:37], v21 offset:8192
    ds_read_b64_tr_b16 a[38:39], v21 offset:9216
    ds_read_b64_tr_b16 a[40:41], v22 offset:8192
    ds_read_b64_tr_b16 a[42:43], v22 offset:9216
    ds_read_b64_tr_b16 a[44:45], v23 offset:8192
    ds_read_b64_tr_b16 a[46:47], v23 offset:9216
    s_waitcnt lgkmcnt(6)
    ds_read_b64_tr_b16 a[48:49], v20 offset:12288
    ds_read_b64_tr_b16 a[50:51], v20 offset:13312
    ds_read_b64_tr_b16 a[52:53], v21 offset:12288
    ds_read_b64_tr_b16 a[54:55], v21 offset:13312
    ds_read_b64_tr_b16 a[56:57], v22 offset:12288
    ds_read_b64_tr_b16 a[58:59], v22 offset:13312
    ds_read_b64_tr_b16 a[60:61], v23 offset:12288
    ds_read_b64_tr_b16 a[62:63], v23 offset:13312
    s_waitcnt lgkmcnt(6)
    ds_read_b64_tr_b16 a[64:65], v20 offset:16384
    ds_read_b64_tr_b16 a[66:67], v20 offset:17408
    ds_read_b64_tr_b16 a[68:69], v21 offset:16384
    ds_read_b64_tr_b16 a[70:71], v21 offset:17408
    ds_read_b64_tr_b16 a[72:73], v22 offset:16384
    ds_read_b64_tr_b16 a[74:75], v22 offset:17408
    ds_read_b64_tr_b16 a[76:77], v23 offset:16384
    ds_read_b64_tr_b16 a[78:79], v23 offset:17408
    s_waitcnt lgkmcnt(6)
    ds_read_b64_tr_b16 a[80:81], v20 offset:20480
    ds_read_b64_tr_b16 a[82:83], v20 offset:21504
    ds_read_b64_tr_b16 a[84:85], v21 offset:20480
    ds_read_b64_tr_b16 a[86:87], v21 offset:21504
    ds_read_b64_tr_b16 a[88:89], v22 offset:20480
    ds_read_b64_tr_b16 a[90:91], v22 offset:21504
    ds_read_b64_tr_b16 a[92:93], v23 offset:20480
    ds_read_b64_tr_b16 a[94:95], v23 offset:21504
    s_cmp_ge_u32 s49, 14
    s_cbranch_scc1 L_nobf
    s_barrier
    s_add_u32 m0, s55, 143360
    s_add_u32 s57, s85, 720896
    buffer_load_dwordx4 v17, s[32:35], s57 offen lds
    s_add_u32 m0, s55, 147456
    s_add_u32 s57, s85, 786432
    buffer_load_dwordx4 v17, s[32:35], s57 offen lds
    s_add_u32 m0, s55, 151552
    s_add_u32 s57, s85, 851968
    buffer_load_dwordx4 v17, s[32:35], s57 offen lds
L_nobf:
    s_waitcnt vmcnt(3)
    ds_write_b32 v14, v15 offset:16
L_sy1:
    ds_read_b128 v[40:43], v16 offset:16
    s_waitcnt lgkmcnt(0)
    v_and_b32 v40, v40, v41
    v_and_b32 v42, v42, v43
    v_and_b32 v40, v40, v42
    v_cmp_eq_u32 vcc, 0, v40
    s_cbranch_vccnz L_sy1
    ds_read_b64_tr_b16 a[96:97], v20 offset:24576
    ds_read_b64_tr_b16 a[98:99], v20 offset:25600
    ds_read_b64_tr_b16 a[100:101], v21 offset:24576
    ds_read_b64_tr_b16 a[102:103], v21 offset:25600
    ds_read_b64_tr_b16 a[104:105], v22 offset:24576
    ds_read_b64_tr_b16 a[106:107], v22 offset:25600
    ds_read_b64_tr_b16 a[108:109], v23 offset:24576
    ds_read_b64_tr_b16 a[110:111], v23 offset:25600
    s_waitcnt lgkmcnt(6)
    ds_read_b64_tr_b16 a[112:113], v20 offset:28672
    ds_read_b64_tr_b16 a[114:115], v20 offset:29696
    ds_read_b64_tr_b16 a[116:117], v21 offset:28672
    ds_read_b64_tr_b16 a[118:119], v21 offset:29696
    ds_read_b64_tr_b16 a[120:121], v22 offset:28672
    ds_read_b64_tr_b16 a[122:123], v22 offset:29696
    ds_read_b64_tr_b16 a[124:125], v23 offset:28672
    ds_read_b64_tr_b16 a[126:127], v23 offset:29696
    s_waitcnt lgkmcnt(6)
    ds_read_b64_tr_b16 a[128:129], v20 offset:32768
    ds_read_b64_tr_b16 a[130:131], v20 offset:33792
    ds_read_b64_tr_b16 a[132:133], v21 offset:32768
    ds_read_b64_tr_b16 a[134:135], v21 offset:33792
    ds_read_b64_tr_b16 a[136:137], v22 offset:32768
    ds_read_b64_tr_b16 a[138:139], v22 offset:33792
    ds_read_b64_tr_b16 a[140:141], v23 offset:32768
    ds_read_b64_tr_b16 a[142:143], v23 offset:33792
    s_waitcnt lgkmcnt(6)
    ds_read_b64_tr_b16 a[144:145], v20 offset:36864
    ds_read_b64_tr_b16 a[146:147], v20 offset:37888
    ds_read_b64_tr_b16 a[148:149], v21 offset:36864
    ds_read_b64_tr_b16 a[150:151], v21 offset:37888
    ds_read_b64_tr_b16 a[152:153], v22 offset:36864
    ds_read_b64_tr_b16 a[154:155], v22 offset:37888
    ds_read_b64_tr_b16 a[156:157], v23 offset:36864
    ds_read_b64_tr_b16 a[158:159], v23 offset:37888
    s_waitcnt lgkmcnt(6)
    ds_read_b64_tr_b16 v[64:65], v20 offset:40960
    ds_read_b64_tr_b16 v[66:67], v20 offset:41984
    ds_read_b64_tr_b16 v[68:69], v21 offset:40960
    ds_read_b64_tr_b16 v[70:71], v21 offset:41984
    ds_read_b64_tr_b16 v[72:73], v22 offset:40960
    ds_read_b64_tr_b16 v[74:75], v22 offset:41984
    ds_read_b64_tr_b16 v[76:77], v23 offset:40960
    ds_read_b64_tr_b16 v[78:79], v23 offset:41984
    s_cmp_lt_u32 s49, 14
    s_cbranch_scc1 L_nob2
    s_barrier
L_nob2:
    s_waitcnt lgkmcnt(8)
    s_barrier
    ds_read_b128 v[40:43], v19 offset:0
    s_waitcnt lgkmcnt(0)
    s_barrier
    v_mfma_f32_16x16x32_bf16 v[24:27], a[0:3], v[40:43], 0
    ds_read_b128 v[44:47], v19 offset:4096
    v_mfma_f32_16x16x32_bf16 v[28:31], a[4:7], v[40:43], 0
    ds_read_b128 v[48:51], v19 offset:8192
    v_mfma_f32_16x16x32_bf16 v[32:35], a[8:11], v[40:43], 0
    v_mfma_f32_16x16x32_bf16 v[36:39], a[12:15], v[40:43], 0
    s_waitcnt lgkmcnt(0)
    s_barrier
    v_mfma_f32_16x16x32_bf16 v[24:27], a[16:19], v[44:47], v[24:27]
    ds_read_b128 v[52:55], v19 offset:12288
    v_mfma_f32_16x16x32_bf16 v[28:31], a[20:23], v[44:47], v[28:31]
    ds_read_b128 v[56:59], v19 offset:16384
    v_mfma_f32_16x16x32_bf16 v[32:35], a[24:27], v[44:47], v[32:35]
    v_mfma_f32_16x16x32_bf16 v[36:39], a[28:31], v[44:47], v[36:39]
    v_mfma_f32_16x16x32_bf16 v[24:27], a[32:35], v[48:51], v[24:27]
    v_mfma_f32_16x16x32_bf16 v[28:31], a[36:39], v[48:51], v[28:31]
    v_mfma_f32_16x16x32_bf16 v[32:35], a[40:43], v[48:51], v[32:35]
    v_mfma_f32_16x16x32_bf16 v[36:39], a[44:47], v[48:51], v[36:39]
    s_waitcnt vmcnt(2) lgkmcnt(0)
    s_barrier
    v_mfma_f32_16x16x32_bf16 v[24:27], a[48:51], v[52:55], v[24:27]
    ds_read_b128 v[60:63], v19 offset:20480
    v_mfma_f32_16x16x32_bf16 v[28:31], a[52:55], v[52:55], v[28:31]
    ds_read_b128 v[40:43], v19 offset:24576
    v_mfma_f32_16x16x32_bf16 v[32:35], a[56:59], v[52:55], v[32:35]
    ds_read_b64_tr_b16 v[80:81], v20 offset:45056
    v_mfma_f32_16x16x32_bf16 v[36:39], a[60:63], v[52:55], v[36:39]
    ds_read_b64_tr_b16 v[82:83], v20 offset:46080
    v_mfma_f32_16x16x32_bf16 v[24:27], a[64:67], v[56:59], v[24:27]
    ds_read_b64_tr_b16 v[84:85], v21 offset:45056
    v_mfma_f32_16x16x32_bf16 v[28:31], a[68:71], v[56:59], v[28:31]
    ds_read_b64_tr_b16 v[86:87], v21 offset:46080
    v_mfma_f32_16x16x32_bf16 v[32:35], a[72:75], v[56:59], v[32:35]
    ds_read_b64_tr_b16 v[88:89], v22 offset:45056
    v_mfma_f32_16x16x32_bf16 v[36:39], a[76:79], v[56:59], v[36:39]
    ds_read_b64_tr_b16 v[90:91], v22 offset:46080
    s_waitcnt vmcnt(1) lgkmcnt(6)
    s_barrier
    v_mfma_f32_16x16x32_bf16 v[24:27], a[80:83], v[60:63], v[24:27]
    ds_read_b128 v[44:47], v19 offset:28672
    v_mfma_f32_16x16x32_bf16 v[28:31], a[84:87], v[60:63], v[28:31]
    ds_read_b128 v[48:51], v19 offset:32768
    v_mfma_f32_16x16x32_bf16 v[32:35], a[88:91], v[60:63], v[32:35]
    ds_read_b64_tr_b16 v[92:93], v23 offset:45056
    v_mfma_f32_16x16x32_bf16 v[36:39], a[92:95], v[60:63], v[36:39]
    ds_read_b64_tr_b16 v[94:95], v23 offset:46080
    v_mfma_f32_16x16x32_bf16 v[24:27], a[96:99], v[40:43], v[24:27]
    ds_read_b64_tr_b16 a[0:1], v20 offset:49152
    v_mfma_f32_16x16x32_bf16 v[28:31], a[100:103], v[40:43], v[28:31]
    ds_read_b64_tr_b16 a[2:3], v20 offset:50176
    v_mfma_f32_16x16x32_bf16 v[32:35], a[104:107], v[40:43], v[32:35]
    ds_read_b64_tr_b16 a[4:5], v21 offset:49152
    v_mfma_f32_16x16x32_bf16 v[36:39], a[108:111], v[40:43], v[36:39]
    ds_read_b64_tr_b16 a[6:7], v21 offset:50176
    s_waitcnt vmcnt(0) lgkmcnt(6)
    s_barrier
    v_mfma_f32_16x16x32_bf16 v[24:27], a[112:115], v[44:47], v[24:27]
    ds_read_b128 v[52:55], v19 offset:36864
    v_mfma_f32_16x16x32_bf16 v[28:31], a[116:119], v[44:47], v[28:31]
    ds_read_b128 v[56:59], v19 offset:40960
    v_mfma_f32_16x16x32_bf16 v[32:35], a[120:123], v[44:47], v[32:35]
    ds_read_b64_tr_b16 a[8:9], v22 offset:49152
    v_mfma_f32_16x16x32_bf16 v[36:39], a[124:127], v[44:47], v[36:39]
    ds_read_b64_tr_b16 a[10:11], v22 offset:50176
    v_mfma_f32_16x16x32_bf16 v[24:27], a[128:131], v[48:51], v[24:27]
    ds_read_b64_tr_b16 a[12:13], v23 offset:49152
    v_mfma_f32_16x16x32_bf16 v[28:31], a[132:135], v[48:51], v[28:31]
    ds_read_b64_tr_b16 a[14:15], v23 offset:50176
    v_mfma_f32_16x16x32_bf16 v[32:35], a[136:139], v[48:51], v[32:35]
    ds_read_b64_tr_b16 a[16:17], v20 offset:53248
    v_mfma_f32_16x16x32_bf16 v[36:39], a[140:143], v[48:51], v[36:39]
    ds_read_b64_tr_b16 a[18:19], v20 offset:54272
    s_waitcnt lgkmcnt(6)
    s_barrier
    v_mfma_f32_16x16x32_bf16 v[24:27], a[144:147], v[52:55], v[24:27]
    ds_read_b128 v[60:63], v19 offset:45056
    ds_read_b128 v[40:43], v19 offset:49152
    v_mfma_f32_16x16x32_bf16 v[28:31], a[148:151], v[52:55], v[28:31]
    ds_read_b32 v9, v16 offset:36
    v_mfma_f32_16x16x32_bf16 v[32:35], a[152:155], v[52:55], v[32:35]
    ds_read_b64_tr_b16 a[20:21], v21 offset:53248
    v_mfma_f32_16x16x32_bf16 v[36:39], a[156:159], v[52:55], v[36:39]
    ds_read_b64_tr_b16 a[22:23], v21 offset:54272
    v_mfma_f32_16x16x32_bf16 v[24:27], v[64:67], v[56:59], v[24:27]
    ds_read_b64_tr_b16 a[24:25], v22 offset:53248
    v_mfma_f32_16x16x32_bf16 v[28:31], v[68:71], v[56:59], v[28:31]
    ds_read_b64_tr_b16 a[26:27], v22 offset:54272
    v_mfma_f32_16x16x32_bf16 v[32:35], v[72:75], v[56:59], v[32:35]
    ds_read_b64_tr_b16 a[28:29], v23 offset:53248
    v_mfma_f32_16x16x32_bf16 v[36:39], v[76:79], v[56:59], v[36:39]
    ds_read_b64_tr_b16 a[30:31], v23 offset:54272
    s_waitcnt lgkmcnt(7)
    s_barrier
    v_mfma_f32_16x16x32_bf16 v[24:27], v[80:83], v[60:63], v[24:27]
    ds_read_b128 v[44:47], v19 offset:53248
    v_mfma_f32_16x16x32_bf16 v[28:31], v[84:87], v[60:63], v[28:31]
    v_mfma_f32_16x16x32_bf16 v[32:35], v[88:91], v[60:63], v[32:35]
    v_mfma_f32_16x16x32_bf16 v[36:39], v[92:95], v[60:63], v[36:39]
    v_mfma_f32_16x16x32_bf16 v[24:27], a[0:3], v[40:43], v[24:27]
    v_mfma_f32_16x16x32_bf16 v[28:31], a[4:7], v[40:43], v[28:31]
    v_mfma_f32_16x16x32_bf16 v[32:35], a[8:11], v[40:43], v[32:35]
    v_mfma_f32_16x16x32_bf16 v[36:39], a[12:15], v[40:43], v[36:39]
    s_waitcnt lgkmcnt(0)
    v_mfma_f32_16x16x32_bf16 v[24:27], a[16:19], v[44:47], v[24:27]
    v_cmp_ne_u32 vcc, v5, v9
    v_mfma_f32_16x16x32_bf16 v[28:31], a[20:23], v[44:47], v[28:31]
    s_mov_b32 s80, 0
    s_mov_b32 s44, 0xffff0000
    v_mfma_f32_16x16x32_bf16 v[32:35], a[24:27], v[44:47], v[32:35]
    s_cbranch_vccnz L_pz_wait
L_pz_ok:
    v_mfma_f32_16x16x32_bf16 v[36:39], a[28:31], v[44:47], v[36:39]
    s_nop 0
    v_cvt_pk_bf16_f32 v40, v24, v25
    v_cvt_pk_bf16_f32 v41, v26, v27
    s_nop 1
    v_cvt_pk_bf16_f32 v42, v28, v29
    v_cvt_pk_bf16_f32 v43, v30, v31
    v_min_u32 v40, -2, v40
    v_min_u32 v41, -2, v41
    v_min_u32 v42, -2, v42
    v_min_u32 v43, -2, v43
    buffer_store_dwordx4 v[40:43], v8, s[36:39], 0 offen offset:0 sc1
    v_cvt_pk_bf16_f32 v44, v32, v33
    v_cvt_pk_bf16_f32 v45, v34, v35
    v_cvt_pk_bf16_f32 v46, v36, v37
    v_cvt_pk_bf16_f32 v47, v38, v39
    v_min_u32 v44, -2, v44
    v_min_u32 v45, -2, v45
    v_min_u32 v46, -2, v46
    v_min_u32 v47, -2, v47
    buffer_store_dwordx4 v[44:47], v8, s[36:39], 0 offen offset:512 sc1
    s_waitcnt vmcnt(0)
L_poll2:
    buffer_load_dwordx4 v[64:67], v6, s[36:39], 0 offen sc1
    buffer_load_dwordx4 v[68:71], v6, s[36:39], 0 offen offset:1024 sc1
    s_add_u32 s80, s80, 1
    s_cmp_ge_u32 s80, 262144
    s_waitcnt vmcnt(1)
    v_max3_u32 v4, v64, v65, v66
    v_lshlrev_b32 v72, 16, v64
    v_and_b32 v73, s44, v64
    v_lshlrev_b32 v74, 16, v65
    v_and_b32 v75, s44, v65
    v_lshlrev_b32 v76, 16, v66
    v_and_b32 v77, s44, v66
    v_lshlrev_b32 v78, 16, v67
    v_and_b32 v79, s44, v67
    s_waitcnt vmcnt(0)
    v_max3_u32 v4, v4, v67, v68
    v_max3_u32 v5, v69, v70, v71
    v_max_u32 v4, v4, v5
    v_cmp_eq_u32 vcc, -1, v4
    s_cbranch_scc1 L_fin
    s_cbranch_vccnz L_poll2
L_fin:
    v_lshlrev_b32 v80, 16, v68
    v_and_b32 v81, s44, v68
    v_lshlrev_b32 v82, 16, v69
    v_and_b32 v83, s44, v69
    v_lshlrev_b32 v84, 16, v70
    v_and_b32 v85, s44, v70
    v_lshlrev_b32 v86, 16, v71
    v_and_b32 v87, s44, v71
    v_pk_add_f32 v[72:73], v[72:73], v[80:81]
    v_pk_add_f32 v[76:77], v[76:77], v[84:85]
    v_pk_add_f32 v[74:75], v[74:75], v[82:83]
    v_pk_add_f32 v[78:79], v[78:79], v[86:87]
    s_nop 0
    v_permlane32_swap_b32 v72, v76
    v_permlane32_swap_b32 v73, v77
    v_permlane32_swap_b32 v74, v78
    v_permlane32_swap_b32 v75, v79
    v_pk_add_f32 v[72:73], v[72:73], v[76:77]
    v_pk_add_f32 v[74:75], v[74:75], v[78:79]
    s_nop 1
    v_permlane16_swap_b32 v72, v74
    v_permlane16_swap_b32 v73, v75
    s_nop 0
    v_pk_add_f32 v[72:73], v[72:73], v[74:75]
    v_cvt_pk_bf16_f32 v64, v72, v73
    buffer_store_dword v64, v7, s[40:43], 0 offen
L_end:
    s_endpgm
L_pz_wait:
    s_sleep 4
    buffer_load_dword v9, v18, s[36:39], 0 offen sc1
    s_add_u32 s80, s80, 1
    s_cmp_ge_u32 s80, 262144
    s_waitcnt vmcnt(0)
    v_cmp_ne_u32 vcc, v5, v9
    s_cbranch_scc1 L_pz_out
    s_cbranch_vccnz L_pz_wait
L_pz_out:
    s_mov_b32 s80, 0
    s_branch L_pz_ok
L_front_go_on:
    s_waitcnt lgkmcnt(0)
    s_movk_i32 s88, 8192
    s_load_dword s59, s[16:17], s88
    s_load_dword s87, s[14:15], 0
    v_add_u32 v17, 49152, v16
    v_add_u32 v24, 49152, v20
    v_add_u32 v25, 49152, v21
    v_add_u32 v26, 49152, v22
    v_add_u32 v27, 49152, v23
    v_lshrrev_b32 v6, 1, v1
    s_lshl_b32 s54, s52, 1
    v_add_u32 v6, s54, v6
    v_lshlrev_b32 v6, 3, v6
    v_bfe_u32 v7, v2, 4, 1
    s_lshl_b32 s54, s47, 2
    v_add3_u32 v6, v6, v7, s54
    v_lshlrev_b32 v6, 10, v6
    v_and_b32 v7, 1, v1
    v_lshl_add_u32 v7, v7, 1, v5
    v_lshl_add_u32 v6, v7, 8, v6
    v_and_b32 v7, 15, v2
    v_lshl_add_u32 v14, v7, 4, v6
    v_add_u32 v14, 65536, v14
    s_lshl_b32 s54, s48, 1
    s_add_u32 s54, s54, s47
    s_lshl_b32 s54, s54, 7
    s_lshr_b32 s57, s49, 1
    s_lshl_b32 s57, s57, 4
    s_add_u32 s54, s54, s57
    s_add_u32 s54, s54, 0
    v_lshl_add_u32 v15, v1, 2, s54
    s_mov_b32 s44, 0xbfb8aa3b
    s_mov_b32 s45, 0xbfb8aa3b
    s_mov_b32 s90, 1
    s_mov_b32 s50, 0
    s_cmp_ge_u32 s49, 3
    s_addc_u32 s51, s49, 0
    s_cmp_ge_u32 s49, 10
    s_addc_u32 s51, s51, 0
    s_mov_b32 s46, 0
    s_getreg_b32 s86, hwreg(HW_REG_XCC_ID, 0, 4)
    s_lshl_b32 s86, s86, 24
    s_lshl_b32 s55, s53, 10
    s_lshl_b32 s82, s46, 13
    s_sub_u32 s83, 0, s82
    s_mul_i32 s54, s48, 112
    s_lshl_b32 s57, s50, 2
    s_add_u32 s54, s54, s57
    v_add_u32 v6, s54, v1
    v_lshlrev_b32 v6, 10, v6
    v_lshl_add_u32 v19, v2, 4, v6
    v_add_u32 v19, 65536, v19
    s_lshl_b32 s54, s48, 1
    s_add_u32 s54, s54, s50
    s_lshl_b32 s54, s54, 7
    s_add_u32 s54, s54, 0
    v_min_u32 v6, 27, v2
    v_lshl_add_u32 v18, v6, 2, s54
    s_lshl_b32 s54, s48, 7
    s_add_u32 s54, s54, 12288
    v_and_b32 v6, 31, v2
    v_lshl_add_u32 v29, v6, 2, s54
    v_and_b32 v7, 1, v6
    v_lshlrev_b32 v7, 7, v7
    v_lshrrev_b32 v8, 1, v6
    v_lshl_add_u32 v7, v8, 4, v7
    v_cmp_gt_u32 vcc, 14, v6
    s_lshl_b32 s54, s48, 8
    s_add_u32 s54, s54, 0
    v_add_u32 v7, s54, v7
    v_cndmask_b32 v29, v29, v7, vcc
    s_cmp_lt_u32 s49, 14
    s_cselect_b32 s54, 14, 0
    s_add_u32 s54, s54, s49
    s_lshl_b32 s54, s54, 10
    s_add_u32 s91, s54, 16384
    s_mov_b32 s38, 268435456
    s_mov_b32 s39, 0x20000
    s_mov_b64 s[36:37], s[16:17]
    s_barrier
    ds_read_b64_tr_b16 a[0:1], v16 offset:0
    ds_read_b64_tr_b16 a[2:3], v16 offset:512
    ds_read_b128 a[4:7], v20 offset:0
    ds_read_b128 a[8:11], v20 offset:4096
    ds_read_b64_tr_b16 a[12:13], v16 offset:2048
    ds_read_b64_tr_b16 a[14:15], v16 offset:2560
    ds_read_b128 a[16:19], v21 offset:0
    ds_read_b128 a[20:23], v21 offset:4096
    ds_read_b64_tr_b16 a[24:25], v16 offset:4096
    ds_read_b64_tr_b16 a[26:27], v16 offset:4608
    ds_read_b128 a[28:31], v22 offset:0
    ds_read_b128 a[32:35], v22 offset:4096
    s_waitcnt lgkmcnt(8)
    v_mfma_f32_32x32x16_bf16 v[32:47], a[0:3], a[4:7], 0
    ds_read_b64_tr_b16 a[36:37], v16 offset:6144
    ds_read_b64_tr_b16 a[38:39], v16 offset:6656
    v_mfma_f32_32x32x16_bf16 v[48:63], a[0:3], a[8:11], 0
    ds_read_b128 a[40:43], v23 offset:0
    ds_read_b128 a[44:47], v23 offset:4096
    s_waitcnt lgkmcnt(8)
    v_mfma_f32_32x32x16_bf16 v[32:47], a[12:15], a[16:19], v[32:47]
    v_mfma_f32_32x32x16_bf16 v[48:63], a[12:15], a[20:23], v[48:63]
    s_waitcnt lgkmcnt(4)
    v_mfma_f32_32x32x16_bf16 v[32:47], a[24:27], a[28:31], v[32:47]
    v_mfma_f32_32x32x16_bf16 v[48:63], a[24:27], a[32:35], v[48:63]
    s_waitcnt lgkmcnt(0)
    s_barrier
    ds_read_b64_tr_b16 a[0:1], v16 offset:24576
    ds_read_b64_tr_b16 a[2:3], v16 offset:25088
    ds_read_b128 a[4:7], v20 offset:24576
    ds_read_b128 a[8:11], v20 offset:28672
    v_mfma_f32_32x32x16_bf16 v[32:47], a[36:39], a[40:43], v[32:47]
    ds_read_b64_tr_b16 a[12:13], v16 offset:26624
    ds_read_b64_tr_b16 a[14:15], v16 offset:27136
    ds_read_b128 a[16:19], v21 offset:24576
    ds_read_b128 a[20:23], v21 offset:28672
    v_mfma_f32_32x32x16_bf16 v[48:63], a[36:39], a[44:47], v[48:63]
    ds_read_b64_tr_b16 a[24:25], v16 offset:28672
    ds_read_b64_tr_b16 a[26:27], v16 offset:29184
    ds_read_b128 a[28:31], v22 offset:24576
    ds_read_b128 a[32:35], v22 offset:28672
    s_waitcnt lgkmcnt(8)
    v_mfma_f32_32x32x16_bf16 v[32:47], a[0:3], a[4:7], v[32:47]
    ds_read_b64_tr_b16 a[36:37], v16 offset:30720
    ds_read_b64_tr_b16 a[38:39], v16 offset:31232
    v_mfma_f32_32x32x16_bf16 v[48:63], a[0:3], a[8:11], v[48:63]
    ds_read_b128 a[40:43], v23 offset:24576
    ds_read_b128 a[44:47], v23 offset:28672
    s_waitcnt lgkmcnt(8)
    v_mfma_f32_32x32x16_bf16 v[32:47], a[12:15], a[16:19], v[32:47]
    v_mfma_f32_32x32x16_bf16 v[48:63], a[12:15], a[20:23], v[48:63]
    s_waitcnt lgkmcnt(4)
    v_mfma_f32_32x32x16_bf16 v[32:47], a[24:27], a[28:31], v[32:47]
    v_mfma_f32_32x32x16_bf16 v[48:63], a[24:27], a[32:35], v[48:63]
    s_waitcnt lgkmcnt(0)
    s_barrier
    ds_read_b64_tr_b16 a[0:1], v17 offset:0
    ds_read_b64_tr_b16 a[2:3], v17 offset:512
    ds_read_b128 a[4:7], v24 offset:0
    ds_read_b128 a[8:11], v24 offset:4096
    v_mfma_f32_32x32x16_bf16 v[32:47], a[36:39], a[40:43], v[32:47]
    ds_read_b64_tr_b16 a[12:13], v17 offset:2048
    ds_read_b64_tr_b16 a[14:15], v17 offset:2560
    ds_read_b128 a[16:19], v25 offset:0
    ds_read_b128 a[20:23], v25 offset:4096
    v_mfma_f32_32x32x16_bf16 v[48:63], a[36:39], a[44:47], v[48:63]
    ds_read_b64_tr_b16 a[24:25], v17 offset:4096
    ds_read_b64_tr_b16 a[26:27], v17 offset:4608
    ds_read_b128 a[28:31], v26 offset:0
    ds_read_b128 a[32:35], v26 offset:4096
    s_waitcnt lgkmcnt(8)
    v_mfma_f32_32x32x16_bf16 v[32:47], a[0:3], a[4:7], v[32:47]
    ds_read_b64_tr_b16 a[36:37], v17 offset:6144
    ds_read_b64_tr_b16 a[38:39], v17 offset:6656
    v_mfma_f32_32x32x16_bf16 v[48:63], a[0:3], a[8:11], v[48:63]
    ds_read_b128 a[40:43], v27 offset:0
    ds_read_b128 a[44:47], v27 offset:4096
    s_waitcnt lgkmcnt(8)
    v_mfma_f32_32x32x16_bf16 v[32:47], a[12:15], a[16:19], v[32:47]
    v_mfma_f32_32x32x16_bf16 v[48:63], a[12:15], a[20:23], v[48:63]
    s_waitcnt lgkmcnt(4)
    v_mfma_f32_32x32x16_bf16 v[32:47], a[24:27], a[28:31], v[32:47]
    v_mfma_f32_32x32x16_bf16 v[48:63], a[24:27], a[32:35], v[48:63]
    s_waitcnt lgkmcnt(0)
    s_barrier
    ds_read_b64_tr_b16 a[0:1], v17 offset:24576
    ds_read_b64_tr_b16 a[2:3], v17 offset:25088
    ds_read_b128 a[4:7], v24 offset:24576
    ds_read_b128 a[8:11], v24 offset:28672
    v_mfma_f32_32x32x16_bf16 v[32:47], a[36:39], a[40:43], v[32:47]
    ds_read_b64_tr_b16 a[12:13], v17 offset:26624
    ds_read_b64_tr_b16 a[14:15], v17 offset:27136
    ds_read_b128 a[16:19], v25 offset:24576
    ds_read_b128 a[20:23], v25 offset:28672
    v_mfma_f32_32x32x16_bf16 v[48:63], a[36:39], a[44:47], v[48:63]
    ds_read_b64_tr_b16 a[24:25], v17 offset:28672
    ds_read_b64_tr_b16 a[26:27], v17 offset:29184
    ds_read_b128 a[28:31], v26 offset:24576
    ds_read_b128 a[32:35], v26 offset:28672
    s_waitcnt lgkmcnt(8)
    v_mfma_f32_32x32x16_bf16 v[32:47], a[0:3], a[4:7], v[32:47]
    ds_read_b64_tr_b16 a[36:37], v17 offset:30720
    ds_read_b64_tr_b16 a[38:39], v17 offset:31232
    v_mfma_f32_32x32x16_bf16 v[48:63], a[0:3], a[8:11], v[48:63]
    ds_read_b128 a[40:43], v27 offset:24576
    ds_read_b128 a[44:47], v27 offset:28672
    s_waitcnt lgkmcnt(8)
    v_mfma_f32_32x32x16_bf16 v[32:47], a[12:15], a[16:19], v[32:47]
    v_mfma_f32_32x32x16_bf16 v[48:63], a[12:15], a[20:23], v[48:63]
    s_waitcnt lgkmcnt(4)
    v_mfma_f32_32x32x16_bf16 v[32:47], a[24:27], a[28:31], v[32:47]
    v_mfma_f32_32x32x16_bf16 v[48:63], a[24:27], a[32:35], v[48:63]
    s_waitcnt lgkmcnt(0)
    s_barrier
    ds_read_b64_tr_b16 a[0:1], v16 offset:0
    ds_read_b64_tr_b16 a[2:3], v16 offset:512
    ds_read_b128 a[4:7], v20 offset:0
    ds_read_b128 a[8:11], v20 offset:4096
    v_mfma_f32_32x32x16_bf16 v[32:47], a[36:39], a[40:43], v[32:47]
    ds_read_b64_tr_b16 a[12:13], v16 offset:2048
    ds_read_b64_tr_b16 a[14:15], v16 offset:2560
    ds_read_b128 a[16:19], v21 offset:0
    ds_read_b128 a[20:23], v21 offset:4096
    v_mfma_f32_32x32x16_bf16 v[48:63], a[36:39], a[44:47], v[48:63]
    ds_read_b64_tr_b16 a[24:25], v16 offset:4096
    ds_read_b64_tr_b16 a[26:27], v16 offset:4608
    ds_read_b128 a[28:31], v22 offset:0
    ds_read_b128 a[32:35], v22 offset:4096
    s_waitcnt lgkmcnt(8)
    v_mfma_f32_32x32x16_bf16 v[32:47], a[0:3], a[4:7], v[32:47]
    ds_read_b64_tr_b16 a[36:37], v16 offset:6144
    ds_read_b64_tr_b16 a[38:39], v16 offset:6656
    v_mfma_f32_32x32x16_bf16 v[48:63], a[0:3], a[8:11], v[48:63]
    ds_read_b128 a[40:43], v23 offset:0
    ds_read_b128 a[44:47], v23 offset:4096
    s_waitcnt lgkmcnt(8)
    v_mfma_f32_32x32x16_bf16 v[32:47], a[12:15], a[16:19], v[32:47]
    v_mfma_f32_32x32x16_bf16 v[48:63], a[12:15], a[20:23], v[48:63]
    s_waitcnt lgkmcnt(4)
    v_mfma_f32_32x32x16_bf16 v[32:47], a[24:27], a[28:31], v[32:47]
    v_mfma_f32_32x32x16_bf16 v[48:63], a[24:27], a[32:35], v[48:63]
    s_waitcnt lgkmcnt(0)
    s_barrier
    ds_read_b64_tr_b16 a[0:1], v16 offset:24576
    ds_read_b64_tr_b16 a[2:3], v16 offset:25088
    ds_read_b128 a[4:7], v20 offset:24576
    ds_read_b128 a[8:11], v20 offset:28672
    v_mfma_f32_32x32x16_bf16 v[32:47], a[36:39], a[40:43], v[32:47]
    ds_read_b64_tr_b16 a[12:13], v16 offset:26624
    ds_read_b64_tr_b16 a[14:15], v16 offset:27136
    ds_read_b128 a[16:19], v21 offset:24576
    ds_read_b128 a[20:23], v21 offset:28672
    v_mfma_f32_32x32x16_bf16 v[48:63], a[36:39], a[44:47], v[48:63]
    ds_read_b64_tr_b16 a[24:25], v16 offset:28672
    ds_read_b64_tr_b16 a[26:27], v16 offset:29184
    ds_read_b128 a[28:31], v22 offset:24576
    ds_read_b128 a[32:35], v22 offset:28672
    s_waitcnt lgkmcnt(8)
    v_mfma_f32_32x32x16_bf16 v[32:47], a[0:3], a[4:7], v[32:47]
    ds_read_b64_tr_b16 a[36:37], v16 offset:30720
    ds_read_b64_tr_b16 a[38:39], v16 offset:31232
    v_mfma_f32_32x32x16_bf16 v[48:63], a[0:3], a[8:11], v[48:63]
    ds_read_b128 a[40:43], v23 offset:24576
    ds_read_b128 a[44:47], v23 offset:28672
    s_waitcnt lgkmcnt(8)
    v_mfma_f32_32x32x16_bf16 v[32:47], a[12:15], a[16:19], v[32:47]
    v_mfma_f32_32x32x16_bf16 v[48:63], a[12:15], a[20:23], v[48:63]
    s_waitcnt lgkmcnt(4)
    v_mfma_f32_32x32x16_bf16 v[32:47], a[24:27], a[28:31], v[32:47]
    v_mfma_f32_32x32x16_bf16 v[48:63], a[24:27], a[32:35], v[48:63]
    s_waitcnt lgkmcnt(0)
    s_barrier
    ds_read_b64_tr_b16 a[0:1], v17 offset:0
    ds_read_b64_tr_b16 a[2:3], v17 offset:512
    ds_read_b128 a[4:7], v24 offset:0
    ds_read_b128 a[8:11], v24 offset:4096
    v_mfma_f32_32x32x16_bf16 v[32:47], a[36:39], a[40:43], v[32:47]
    ds_read_b64_tr_b16 a[12:13], v17 offset:2048
    ds_read_b64_tr_b16 a[14:15], v17 offset:2560
    ds_read_b128 a[16:19], v25 offset:0
    ds_read_b128 a[20:23], v25 offset:4096
    v_mfma_f32_32x32x16_bf16 v[48:63], a[36:39], a[44:47], v[48:63]
    ds_read_b64_tr_b16 a[24:25], v17 offset:4096
    ds_read_b64_tr_b16 a[26:27], v17 offset:4608
    ds_read_b128 a[28:31], v26 offset:0
    ds_read_b128 a[32:35], v26 offset:4096
    s_waitcnt lgkmcnt(8)
    v_mfma_f32_32x32x16_bf16 v[32:47], a[0:3], a[4:7], v[32:47]
    ds_read_b64_tr_b16 a[36:37], v17 offset:6144
    ds_read_b64_tr_b16 a[38:39], v17 offset:6656
    v_mfma_f32_32x32x16_bf16 v[48:63], a[0:3], a[8:11], v[48:63]
    ds_read_b128 a[40:43], v27 offset:0
    ds_read_b128 a[44:47], v27 offset:4096
    s_waitcnt lgkmcnt(8)
    v_mfma_f32_32x32x16_bf16 v[32:47], a[12:15], a[16:19], v[32:47]
    v_mfma_f32_32x32x16_bf16 v[48:63], a[12:15], a[20:23], v[48:63]
    s_waitcnt lgkmcnt(4)
    v_mfma_f32_32x32x16_bf16 v[32:47], a[24:27], a[28:31], v[32:47]
    v_mfma_f32_32x32x16_bf16 v[48:63], a[24:27], a[32:35], v[48:63]
    v_mov_b32 v30, 0
    s_add_u32 s59, s59, 1
    s_bitset1_b32 s59, 31
    global_load_dword v12, v30, s[14:15] sc1
    s_waitcnt lgkmcnt(0)
    s_barrier
    ds_read_b64_tr_b16 a[0:1], v17 offset:24576
    ds_read_b64_tr_b16 a[2:3], v17 offset:25088
    ds_read_b128 a[4:7], v24 offset:24576
    ds_read_b128 a[8:11], v24 offset:28672
    v_mfma_f32_32x32x16_bf16 v[32:47], a[36:39], a[40:43], v[32:47]
    ds_read_b64_tr_b16 a[12:13], v17 offset:26624
    ds_read_b64_tr_b16 a[14:15], v17 offset:27136
    ds_read_b128 a[16:19], v25 offset:24576
    ds_read_b128 a[20:23], v25 offset:28672
    v_mfma_f32_32x32x16_bf16 v[48:63], a[36:39], a[44:47], v[48:63]
    ds_read_b64_tr_b16 a[24:25], v17 offset:28672
    ds_read_b64_tr_b16 a[26:27], v17 offset:29184
    ds_read_b128 a[28:31], v26 offset:24576
    ds_read_b128 a[32:35], v26 offset:28672
    s_waitcnt lgkmcnt(8)
    v_mfma_f32_32x32x16_bf16 v[32:47], a[0:3], a[4:7], v[32:47]
    ds_read_b64_tr_b16 a[36:37], v17 offset:30720
    ds_read_b64_tr_b16 a[38:39], v17 offset:31232
    v_mfma_f32_32x32x16_bf16 v[48:63], a[0:3], a[8:11], v[48:63]
    ds_read_b128 a[40:43], v27 offset:24576
    ds_read_b128 a[44:47], v27 offset:28672
    s_waitcnt lgkmcnt(8)
    v_mfma_f32_32x32x16_bf16 v[32:47], a[12:15], a[16:19], v[32:47]
    v_mfma_f32_32x32x16_bf16 v[48:63], a[12:15], a[20:23], v[48:63]
    s_waitcnt lgkmcnt(4)
    v_mfma_f32_32x32x16_bf16 v[32:47], a[24:27], a[28:31], v[32:47]
    v_mfma_f32_32x32x16_bf16 v[48:63], a[24:27], a[32:35], v[48:63]
    s_waitcnt lgkmcnt(0)
    s_barrier
    ds_read_b64_tr_b16 a[0:1], v16 offset:0
    ds_read_b64_tr_b16 a[2:3], v16 offset:512
    ds_read_b128 a[4:7], v20 offset:0
    ds_read_b128 a[8:11], v20 offset:4096
    v_mfma_f32_32x32x16_bf16 v[32:47], a[36:39], a[40:43], v[32:47]
    ds_read_b64_tr_b16 a[12:13], v16 offset:2048
    ds_read_b64_tr_b16 a[14:15], v16 offset:2560
    ds_read_b128 a[16:19], v21 offset:0
    ds_read_b128 a[20:23], v21 offset:4096
    v_mfma_f32_32x32x16_bf16 v[48:63], a[36:39], a[44:47], v[48:63]
    ds_read_b64_tr_b16 a[24:25], v16 offset:4096
    ds_read_b64_tr_b16 a[26:27], v16 offset:4608
    ds_read_b128 a[28:31], v22 offset:0
    ds_read_b128 a[32:35], v22 offset:4096
    s_waitcnt lgkmcnt(8)
    v_mfma_f32_32x32x16_bf16 v[32:47], a[0:3], a[4:7], v[32:47]
    ds_read_b64_tr_b16 a[36:37], v16 offset:6144
    ds_read_b64_tr_b16 a[38:39], v16 offset:6656
    v_mfma_f32_32x32x16_bf16 v[48:63], a[0:3], a[8:11], v[48:63]
    ds_read_b128 a[40:43], v23 offset:0
    ds_read_b128 a[44:47], v23 offset:4096
    s_waitcnt lgkmcnt(8)
    v_mfma_f32_32x32x16_bf16 v[32:47], a[12:15], a[16:19], v[32:47]
    v_mfma_f32_32x32x16_bf16 v[48:63], a[12:15], a[20:23], v[48:63]
    s_waitcnt lgkmcnt(4)
    v_mfma_f32_32x32x16_bf16 v[32:47], a[24:27], a[28:31], v[32:47]
    v_mfma_f32_32x32x16_bf16 v[48:63], a[24:27], a[32:35], v[48:63]
    s_waitcnt lgkmcnt(0)
    s_barrier
    ds_read_b64_tr_b16 a[0:1], v16 offset:24576
    ds_read_b64_tr_b16 a[2:3], v16 offset:25088
    ds_read_b128 a[4:7], v20 offset:24576
    ds_read_b128 a[8:11], v20 offset:28672
    v_mfma_f32_32x32x16_bf16 v[32:47], a[36:39], a[40:43], v[32:47]
    ds_read_b64_tr_b16 a[12:13], v16 offset:26624
    ds_read_b64_tr_b16 a[14:15], v16 offset:27136
    ds_read_b128 a[16:19], v21 offset:24576
    ds_read_b128 a[20:23], v21 offset:28672
    v_mfma_f32_32x32x16_bf16 v[48:63], a[36:39], a[44:47], v[48:63]
    ds_read_b64_tr_b16 a[24:25], v16 offset:28672
    ds_read_b64_tr_b16 a[26:27], v16 offset:29184
    ds_read_b128 a[28:31], v22 offset:24576
    ds_read_b128 a[32:35], v22 offset:28672
    s_waitcnt lgkmcnt(8)
    v_mfma_f32_32x32x16_bf16 v[32:47], a[0:3], a[4:7], v[32:47]
    ds_read_b64_tr_b16 a[36:37], v16 offset:30720
    ds_read_b64_tr_b16 a[38:39], v16 offset:31232
    v_mfma_f32_32x32x16_bf16 v[48:63], a[0:3], a[8:11], v[48:63]
    ds_read_b128 a[40:43], v23 offset:24576
    ds_read_b128 a[44:47], v23 offset:28672
    s_waitcnt lgkmcnt(8)
    v_mfma_f32_32x32x16_bf16 v[32:47], a[12:15], a[16:19], v[32:47]
    v_mfma_f32_32x32x16_bf16 v[48:63], a[12:15], a[20:23], v[48:63]
    s_waitcnt lgkmcnt(4)
    v_mfma_f32_32x32x16_bf16 v[32:47], a[24:27], a[28:31], v[32:47]
    v_mfma_f32_32x32x16_bf16 v[48:63], a[24:27], a[32:35], v[48:63]
    s_waitcnt lgkmcnt(0)
    s_barrier
    ds_read_b64_tr_b16 a[0:1], v17 offset:0
    ds_read_b64_tr_b16 a[2:3], v17 offset:512
    ds_read_b128 a[4:7], v24 offset:0
    ds_read_b128 a[8:11], v24 offset:4096
    v_mfma_f32_32x32x16_bf16 v[32:47], a[36:39], a[40:43], v[32:47]
    ds_read_b64_tr_b16 a[12:13], v17 offset:2048
    ds_read_b64_tr_b16 a[14:15], v17 offset:2560
    ds_read_b128 a[16:19], v25 offset:0
    ds_read_b128 a[20:23], v25 offset:4096
    v_mfma_f32_32x32x16_bf16 v[48:63], a[36:39], a[44:47], v[48:63]
    ds_read_b64_tr_b16 a[24:25], v17 offset:4096
    ds_read_b64_tr_b16 a[26:27], v17 offset:4608
    ds_read_b128 a[28:31], v26 offset:0
    ds_read_b128 a[32:35], v26 offset:4096
    s_waitcnt lgkmcnt(8)
    v_mfma_f32_32x32x16_bf16 v[32:47], a[0:3], a[4:7], v[32:47]
    ds_read_b64_tr_b16 a[36:37], v17 offset:6144
    ds_read_b64_tr_b16 a[38:39], v17 offset:6656
    v_mfma_f32_32x32x16_bf16 v[48:63], a[0:3], a[8:11], v[48:63]
    ds_read_b128 a[40:43], v27 offset:0
    ds_read_b128 a[44:47], v27 offset:4096
    s_waitcnt lgkmcnt(8)
    v_mfma_f32_32x32x16_bf16 v[32:47], a[12:15], a[16:19], v[32:47]
    v_mfma_f32_32x32x16_bf16 v[48:63], a[12:15], a[20:23], v[48:63]
    s_waitcnt lgkmcnt(4)
    v_mfma_f32_32x32x16_bf16 v[32:47], a[24:27], a[28:31], v[32:47]
    v_mfma_f32_32x32x16_bf16 v[48:63], a[24:27], a[32:35], v[48:63]
    s_waitcnt lgkmcnt(0)
    s_barrier
    ds_read_b64_tr_b16 a[0:1], v17 offset:24576
    ds_read_b64_tr_b16 a[2:3], v17 offset:25088
    ds_read_b128 a[4:7], v24 offset:24576
    ds_read_b128 a[8:11], v24 offset:28672
    v_mfma_f32_32x32x16_bf16 v[32:47], a[36:39], a[40:43], v[32:47]
    ds_read_b64_tr_b16 a[12:13], v17 offset:26624
    ds_read_b64_tr_b16 a[14:15], v17 offset:27136
    ds_read_b128 a[16:19], v25 offset:24576
    ds_read_b128 a[20:23], v25 offset:28672
    v_mfma_f32_32x32x16_bf16 v[48:63], a[36:39], a[44:47], v[48:63]
    ds_read_b64_tr_b16 a[24:25], v17 offset:28672
    ds_read_b64_tr_b16 a[26:27], v17 offset:29184
    ds_read_b128 a[28:31], v26 offset:24576
    ds_read_b128 a[32:35], v26 offset:28672
    s_waitcnt lgkmcnt(8)
    v_mfma_f32_32x32x16_bf16 v[32:47], a[0:3], a[4:7], v[32:47]
    ds_read_b64_tr_b16 a[36:37], v17 offset:30720
    ds_read_b64_tr_b16 a[38:39], v17 offset:31232
    v_mfma_f32_32x32x16_bf16 v[48:63], a[0:3], a[8:11], v[48:63]
    ds_read_b128 a[40:43], v27 offset:24576
    ds_read_b128 a[44:47], v27 offset:28672
    s_waitcnt lgkmcnt(8)
    v_mfma_f32_32x32x16_bf16 v[32:47], a[12:15], a[16:19], v[32:47]
    v_mfma_f32_32x32x16_bf16 v[48:63], a[12:15], a[20:23], v[48:63]
    s_waitcnt lgkmcnt(4)
    v_mfma_f32_32x32x16_bf16 v[32:47], a[24:27], a[28:31], v[32:47]
    v_mfma_f32_32x32x16_bf16 v[48:63], a[24:27], a[32:35], v[48:63]
    s_waitcnt vmcnt(0)
    v_cmp_eq_u32 vcc, 0, v12
    v_mov_b32 v30, s59
    s_nop 0
    v_cndmask_b32 v12, v12, v30, vcc
    v_xor_b32 v3, s86, v12
    s_waitcnt lgkmcnt(0)
    s_barrier
    ds_read_b64_tr_b16 a[0:1], v16 offset:0
    ds_read_b64_tr_b16 a[2:3], v16 offset:512
    ds_read_b128 a[4:7], v20 offset:0
    ds_read_b128 a[8:11], v20 offset:4096
    v_mfma_f32_32x32x16_bf16 v[32:47], a[36:39], a[40:43], v[32:47]
    ds_read_b64_tr_b16 a[12:13], v16 offset:2048
    ds_read_b64_tr_b16 a[14:15], v16 offset:2560
    ds_read_b128 a[16:19], v21 offset:0
    ds_read_b128 a[20:23], v21 offset:4096
    v_mfma_f32_32x32x16_bf16 v[48:63], a[36:39], a[44:47], v[48:63]
    ds_read_b64_tr_b16 a[24:25], v16 offset:4096
    ds_read_b64_tr_b16 a[26:27], v16 offset:4608
    ds_read_b128 a[28:31], v22 offset:0
    ds_read_b128 a[32:35], v22 offset:4096
    s_waitcnt lgkmcnt(8)
    v_mfma_f32_32x32x16_bf16 v[32:47], a[0:3], a[4:7], v[32:47]
    ds_read_b64_tr_b16 a[36:37], v16 offset:6144
    ds_read_b64_tr_b16 a[38:39], v16 offset:6656
    v_mfma_f32_32x32x16_bf16 v[48:63], a[0:3], a[8:11], v[48:63]
    ds_read_b128 a[40:43], v23 offset:0
    ds_read_b128 a[44:47], v23 offset:4096
    s_waitcnt lgkmcnt(8)
    v_mfma_f32_32x32x16_bf16 v[32:47], a[12:15], a[16:19], v[32:47]
    v_mfma_f32_32x32x16_bf16 v[48:63], a[12:15], a[20:23], v[48:63]
    s_waitcnt lgkmcnt(4)
    v_mfma_f32_32x32x16_bf16 v[32:47], a[24:27], a[28:31], v[32:47]
    v_mfma_f32_32x32x16_bf16 v[48:63], a[24:27], a[32:35], v[48:63]
    s_waitcnt lgkmcnt(0)
    s_barrier
    ds_read_b64_tr_b16 a[0:1], v16 offset:24576
    ds_read_b64_tr_b16 a[2:3], v16 offset:25088
    ds_read_b128 a[4:7], v20 offset:24576
    ds_read_b128 a[8:11], v20 offset:28672
    v_mfma_f32_32x32x16_bf16 v[32:47], a[36:39], a[40:43], v[32:47]
    ds_read_b64_tr_b16 a[12:13], v16 offset:26624
    ds_read_b64_tr_b16 a[14:15], v16 offset:27136
    ds_read_b128 a[16:19], v21 offset:24576
    ds_read_b128 a[20:23], v21 offset:28672
    v_mfma_f32_32x32x16_bf16 v[48:63], a[36:39], a[44:47], v[48:63]
    ds_read_b64_tr_b16 a[24:25], v16 offset:28672
    ds_read_b64_tr_b16 a[26:27], v16 offset:29184
    ds_read_b128 a[28:31], v22 offset:24576
    ds_read_b128 a[32:35], v22 offset:28672
    s_waitcnt lgkmcnt(8)
    v_mfma_f32_32x32x16_bf16 v[32:47], a[0:3], a[4:7], v[32:47]
    ds_read_b64_tr_b16 a[36:37], v16 offset:30720
    ds_read_b64_tr_b16 a[38:39], v16 offset:31232
    v_mfma_f32_32x32x16_bf16 v[48:63], a[0:3], a[8:11], v[48:63]
    ds_read_b128 a[40:43], v23 offset:24576
    ds_read_b128 a[44:47], v23 offset:28672
    s_waitcnt lgkmcnt(8)
    v_mfma_f32_32x32x16_bf16 v[32:47], a[12:15], a[16:19], v[32:47]
    v_mfma_f32_32x32x16_bf16 v[48:63], a[12:15], a[20:23], v[48:63]
    s_waitcnt lgkmcnt(4)
    v_mfma_f32_32x32x16_bf16 v[32:47], a[24:27], a[28:31], v[32:47]
    v_mfma_f32_32x32x16_bf16 v[48:63], a[24:27], a[32:35], v[48:63]
    s_waitcnt lgkmcnt(0)
    s_barrier
    ds_read_b64_tr_b16 a[0:1], v17 offset:0
    ds_read_b64_tr_b16 a[2:3], v17 offset:512
    ds_read_b128 a[4:7], v24 offset:0
    ds_read_b128 a[8:11], v24 offset:4096
    v_mfma_f32_32x32x16_bf16 v[32:47], a[36:39], a[40:43], v[32:47]
    ds_read_b64_tr_b16 a[12:13], v17 offset:2048
    ds_read_b64_tr_b16 a[14:15], v17 offset:2560
    ds_read_b128 a[16:19], v25 offset:0
    ds_read_b128 a[20:23], v25 offset:4096
    v_mfma_f32_32x32x16_bf16 v[48:63], a[36:39], a[44:47], v[48:63]
    ds_read_b64_tr_b16 a[24:25], v17 offset:4096
    ds_read_b64_tr_b16 a[26:27], v17 offset:4608
    ds_read_b128 a[28:31], v26 offset:0
    ds_read_b128 a[32:35], v26 offset:4096
    s_waitcnt lgkmcnt(8)
    v_mfma_f32_32x32x16_bf16 v[32:47], a[0:3], a[4:7], v[32:47]
    ds_read_b64_tr_b16 a[36:37], v17 offset:6144
    ds_read_b64_tr_b16 a[38:39], v17 offset:6656
    v_mfma_f32_32x32x16_bf16 v[48:63], a[0:3], a[8:11], v[48:63]
    ds_read_b128 a[40:43], v27 offset:0
    ds_read_b128 a[44:47], v27 offset:4096
    s_waitcnt lgkmcnt(8)
    v_mfma_f32_32x32x16_bf16 v[32:47], a[12:15], a[16:19], v[32:47]
    v_mfma_f32_32x32x16_bf16 v[48:63], a[12:15], a[20:23], v[48:63]
    s_waitcnt lgkmcnt(4)
    v_mfma_f32_32x32x16_bf16 v[32:47], a[24:27], a[28:31], v[32:47]
    v_mfma_f32_32x32x16_bf16 v[48:63], a[24:27], a[32:35], v[48:63]
    s_waitcnt lgkmcnt(0)
    s_barrier
    ds_read_b64_tr_b16 a[0:1], v17 offset:24576
    ds_read_b64_tr_b16 a[2:3], v17 offset:25088
    ds_read_b128 a[4:7], v24 offset:24576
    ds_read_b128 a[8:11], v24 offset:28672
    v_mfma_f32_32x32x16_bf16 v[32:47], a[36:39], a[40:43], v[32:47]
    ds_read_b64_tr_b16 a[12:13], v17 offset:26624
    ds_read_b64_tr_b16 a[14:15], v17 offset:27136
    ds_read_b128 a[16:19], v25 offset:24576
    ds_read_b128 a[20:23], v25 offset:28672
    v_mfma_f32_32x32x16_bf16 v[48:63], a[36:39], a[44:47], v[48:63]
    ds_read_b64_tr_b16 a[24:25], v17 offset:28672
    ds_read_b64_tr_b16 a[26:27], v17 offset:29184
    ds_read_b128 a[28:31], v26 offset:24576
    ds_read_b128 a[32:35], v26 offset:28672
    s_waitcnt lgkmcnt(8)
    v_mfma_f32_32x32x16_bf16 v[32:47], a[0:3], a[4:7], v[32:47]
    ds_read_b64_tr_b16 a[36:37], v17 offset:30720
    ds_read_b64_tr_b16 a[38:39], v17 offset:31232
    ds_read_b128 a[40:43], v27 offset:24576
    ds_read_b128 a[44:47], v27 offset:28672
    s_waitcnt lgkmcnt(8)
    v_mfma_f32_32x32x16_bf16 v[32:47], a[12:15], a[16:19], v[32:47]
    s_waitcnt lgkmcnt(4)
    v_mfma_f32_32x32x16_bf16 v[32:47], a[24:27], a[28:31], v[32:47]
    s_waitcnt lgkmcnt(0)
    v_mfma_f32_32x32x16_bf16 v[32:47], a[36:39], a[40:43], v[32:47]
    v_mfma_f32_32x32x16_bf16 v[48:63], a[0:3], a[8:11], v[48:63]
    s_nop 7
    s_nop 2
    v_mfma_f32_32x32x16_bf16 v[48:63], a[12:15], a[20:23], v[48:63]
    v_pk_mul_f32 v[64:65], v[32:33], s[44:45]
    v_pk_mul_f32 v[66:67], v[34:35], s[44:45]
    v_pk_mul_f32 v[68:69], v[36:37], s[44:45]
    v_pk_mul_f32 v[70:71], v[38:39], s[44:45]
    v_exp_f32 v64, v64
    v_mfma_f32_32x32x16_bf16 v[48:63], a[24:27], a[32:35], v[48:63]
    v_exp_f32 v65, v65
    v_exp_f32 v66, v66
    v_exp_f32 v67, v67
    v_mfma_f32_32x32x16_bf16 v[48:63], a[36:39], a[44:47], v[48:63]
    v_exp_f32 v68, v68
    v_exp_f32 v69, v69
    v_exp_f32 v70, v70
    v_exp_f32 v71, v71
    v_pk_add_f32 v[64:65], v[64:65], 1.0 op_sel_hi:[1,0]
    v_pk_add_f32 v[66:67], v[66:67], 1.0 op_sel_hi:[1,0]
    v_pk_add_f32 v[68:69], v[68:69], 1.0 op_sel_hi:[1,0]
    v_pk_add_f32 v[70:71], v[70:71], 1.0 op_sel_hi:[1,0]
    v_rcp_f32 v64, v64
    v_rcp_f32 v65, v65
    v_rcp_f32 v66, v66
    v_rcp_f32 v67, v67
    v_rcp_f32 v68, v68
    v_rcp_f32 v69, v69
    v_rcp_f32 v70, v70
    v_rcp_f32 v71, v71
    v_pk_mul_f32 v[64:65], v[64:65], v[32:33]
    v_pk_mul_f32 v[66:67], v[66:67], v[34:35]
    v_pk_mul_f32 v[68:69], v[68:69], v[36:37]
    v_pk_mul_f32 v[70:71], v[70:71], v[38:39]
    v_pk_mul_f32 v[64:65], v[64:65], v[40:41]
    v_pk_mul_f32 v[66:67], v[66:67], v[42:43]
    v_pk_mul_f32 v[68:69], v[68:69], v[44:45]
    v_pk_mul_f32 v[70:71], v[70:71], v[46:47]
    v_cvt_pk_bf16_f32 v4, v64, v65
    v_cvt_pk_bf16_f32 v5, v66, v67
    v_cvt_pk_bf16_f32 v6, v68, v69
    v_cvt_pk_bf16_f32 v7, v70, v71
    buffer_store_dwordx4 v[4:7], v14, s[36:39], 0 offen offset:0
    v_pk_mul_f32 v[80:81], v[48:49], s[44:45]
    v_pk_mul_f32 v[82:83], v[50:51], s[44:45]
    v_pk_mul_f32 v[84:85], v[52:53], s[44:45]
    v_pk_mul_f32 v[86:87], v[54:55], s[44:45]
    v_exp_f32 v80, v80
    v_exp_f32 v81, v81
    v_exp_f32 v82, v82
    v_exp_f32 v83, v83
    v_exp_f32 v84, v84
    v_exp_f32 v85, v85
    v_exp_f32 v86, v86
    v_exp_f32 v87, v87
    v_pk_add_f32 v[80:81], v[80:81], 1.0 op_sel_hi:[1,0]
    v_pk_add_f32 v[82:83], v[82:83], 1.0 op_sel_hi:[1,0]
    v_pk_add_f32 v[84:85], v[84:85], 1.0 op_sel_hi:[1,0]
    v_pk_add_f32 v[86:87], v[86:87], 1.0 op_sel_hi:[1,0]
    v_rcp_f32 v80, v80
    v_rcp_f32 v81, v81
    v_rcp_f32 v82, v82
    v_rcp_f32 v83, v83
    v_rcp_f32 v84, v84
    v_rcp_f32 v85, v85
    v_rcp_f32 v86, v86
    v_rcp_f32 v87, v87
    v_pk_mul_f32 v[80:81], v[80:81], v[48:49]
    v_pk_mul_f32 v[82:83], v[82:83], v[50:51]
    v_pk_mul_f32 v[84:85], v[84:85], v[52:53]
    v_pk_mul_f32 v[86:87], v[86:87], v[54:55]
    v_pk_mul_f32 v[80:81], v[80:81], v[56:57]
    v_pk_mul_f32 v[82:83], v[82:83], v[58:59]
    v_pk_mul_f32 v[84:85], v[84:85], v[60:61]
    v_pk_mul_f32 v[86:87], v[86:87], v[62:63]
    v_cvt_pk_bf16_f32 v8, v80, v81
    v_cvt_pk_bf16_f32 v9, v82, v83
    v_cvt_pk_bf16_f32 v10, v84, v85
    v_cvt_pk_bf16_f32 v11, v86, v87
    buffer_store_dwordx4 v[8:11], v14, s[36:39], 0 offen offset:2048
    s_waitcnt vmcnt(0)
    buffer_store_dword v3, v15, s[36:39], 0 offen
    s_barrier
L_hload:
    s_mov_b32 s80, 0
    s_cmp_lg_u32 s53, 0
    s_cbranch_scc1 L_poll1
    v_and_b32 v22, 7, v2
    v_lshl_add_u32 v22, v22, 7, s91
L_pz0:
    buffer_load_dword v21, v22, s[36:39], 0 offen sc1
    buffer_load_dword v20, v18, s[36:39], 0 offen sc1
    s_add_u32 s80, s80, 1
    s_cmp_ge_u32 s80, 32
    s_waitcnt vmcnt(0)
    v_cmp_ne_u32 vcc, v12, v21
    s_cbranch_vccz L_pz0_ok
    s_cbranch_scc1 L_poll1
    v_cmp_ne_u32 vcc, v3, v20
    s_cbranch_vccz L_go
    s_sleep 2
    s_branch L_pz0
L_pz0_ok:
    v_cmp_ne_u32 vcc, v3, v20
    s_mov_b32 m0, 155684
    s_mov_b64 exec, 1
    buffer_load_dword v22, s[36:39], 0 offen sc1 lds
    s_mov_b64 exec, -1
    s_cbranch_vccz L_go
L_poll1:
    buffer_load_dword v20, v18, s[36:39], 0 offen sc1
    s_add_u32 s80, s80, 1
    s_cmp_ge_u32 s80, 32
    s_cbranch_scc1 L_slow
    s_waitcnt vmcnt(0)
    v_cmp_ne_u32 vcc, v3, v20
    s_cbranch_vccz L_go
    s_branch L_poll1
L_go:
    s_add_u32 m0, s55, 0
    s_add_u32 s57, s82, 0
    buffer_load_dwordx4 v19, s[36:39], s57 offen sc1 lds
    s_add_u32 m0, s55, 4096
    s_add_u32 s57, s82, 8192
    buffer_load_dwordx4 v19, s[36:39], s57 offen sc1 lds
    s_add_u32 m0, s55, 8192
    s_add_u32 s57, s82, 16384
    buffer_load_dwordx4 v19, s[36:39], s57 offen sc1 lds
    s_add_u32 m0, s55, 12288
    s_add_u32 s57, s82, 24576
    buffer_load_dwordx4 v19, s[36:39], s57 offen sc1 lds
    s_add_u32 m0, s55, 16384
    s_add_u32 s57, s82, 32768
    buffer_load_dwordx4 v19, s[36:39], s57 offen sc1 lds
    s_waitcnt vmcnt(4)
    s_barrier
    s_add_u32 m0, s55, 20480
    s_add_u32 s57, s82, 40960
    buffer_load_dwordx4 v19, s[36:39], s57 offen sc1 lds
    s_add_u32 m0, s55, 24576
    s_add_u32 s57, s82, 49152
    buffer_load_dwordx4 v19, s[36:39], s57 offen sc1 lds
    s_waitcnt vmcnt(4)
    s_barrier
    s_add_u32 m0, s55, 28672
    s_add_u32 s57, s83, 57344
    buffer_load_dwordx4 v19, s[36:39], s57 offen sc1 lds
    s_add_u32 m0, s55, 32768
    s_add_u32 s57, s83, 65536
    buffer_load_dwordx4 v19, s[36:39], s57 offen sc1 lds
    s_waitcnt vmcnt(4)
    s_barrier
    s_add_u32 m0, s55, 36864
    s_add_u32 s57, s83, 73728
    buffer_load_dwordx4 v19, s[36:39], s57 offen sc1 lds
    s_add_u32 m0, s55, 40960
    s_add_u32 s57, s83, 81920
    buffer_load_dwordx4 v19, s[36:39], s57 offen sc1 lds
    s_waitcnt vmcnt(4)
    s_barrier
    s_add_u32 m0, s55, 45056
    s_add_u32 s57, s83, 90112
    buffer_load_dwordx4 v19, s[36:39], s57 offen sc1 lds
    s_add_u32 m0, s55, 49152
    s_add_u32 s57, s83, 98304
    buffer_load_dwordx4 v19, s[36:39], s57 offen sc1 lds
    s_waitcnt vmcnt(4)
    s_barrier
    s_add_u32 m0, s55, 53248
    s_add_u32 s57, s83, 106496
    buffer_load_dwordx4 v19, s[36:39], s57 offen sc1 lds
    s_waitcnt vmcnt(3)
    s_barrier
    s_waitcnt vmcnt(1)
    s_barrier
    s_waitcnt vmcnt(0)
    s_barrier
    s_cmp_eq_u32 s90, 0
    s_cbranch_scc1 L_nob
    buffer_load_dword v20, v29, s[36:39], 0 offen sc1
    s_waitcnt vmcnt(0)
    v_cmp_ne_u32 vcc, v3, v20
    s_cbranch_vccz L_nob
    s_mov_b32 s57, 3145728
    s_movk_i32 s58, 4096
    buffer_store_dwordx4 v[4:7], v14, s[36:39], s57 offen sc1
    buffer_store_dwordx4 v[8:11], v14, s[36:39], s57 offen offset:2048 sc1
    s_waitcnt vmcnt(0)
    buffer_store_dword v12, v15, s[36:39], s58 offen sc1
L_nob:
    s_endpgm
L_slow:
    s_cmp_eq_u32 s90, 0
    s_cbranch_scc1 L_slow_sent
    s_mov_b32 s57, 3145728
    s_movk_i32 s58, 4096
    buffer_store_dwordx4 v[4:7], v14, s[36:39], s57 offen sc1
    buffer_store_dwordx4 v[8:11], v14, s[36:39], s57 offen offset:2048 sc1
    s_waitcnt vmcnt(0)
    buffer_store_dword v12, v15, s[36:39], s58 offen sc1
    s_mov_b32 s90, 0
L_slow_sent:
    s_movk_i32 s57, 4096
    s_mov_b32 s80, 0
L_slow_poll:
    buffer_load_dword v20, v18, s[36:39], 0 offen sc1
    buffer_load_dword v21, v18, s[36:39], s57 offen sc1
    s_add_u32 s80, s80, 1
    s_waitcnt vmcnt(0)
    v_cmp_ne_u32 vcc, v3, v20
    s_cbranch_vccz L_go
    v_cmp_ne_u32 vcc, v12, v21
    s_cbranch_vccz L_slow_b
    s_sleep 8
    s_cmp_lt_u32 s80, 262144
    s_cbranch_scc1 L_slow_poll
L_slow_b:
    s_add_u32 s82, s82, 3145728
    s_add_u32 s83, s83, 3145728
    s_branch L_go
L_code_end:
.section .rodata,"a"
.p2align 6
.amdhsa_kernel standalone__swiglu_ffn__sampling_kernel
  .amdhsa_next_free_vgpr 256
  .amdhsa_next_free_sgpr 96
  .amdhsa_accum_offset 96
  .amdhsa_group_segment_fixed_size 0
  .amdhsa_kernarg_size 56
  .amdhsa_user_sgpr_count 2
  .amdhsa_user_sgpr_kernarg_segment_ptr 1
  .amdhsa_system_sgpr_workgroup_id_x 1
.end_amdhsa_kernel
```
